```python
import torch

def _softmax(x, axis=-1):
    return torch.softmax(x, dim=axis)
def _gelu(x):
    return torch.nn.functional.gelu(x, approximate="tanh")
def _silu(x):
    return torch.nn.functional.silu(x)
def _sigmoid(x):
    return torch.sigmoid(x)
def _layernorm(x, axis=-1, eps=1e-5):
    m = x.mean(dim=axis, keepdim=True)
    v = x.var(dim=axis, keepdim=True, unbiased=False)
    return (x - m) / torch.sqrt(v + eps)
def _scatter_add(tgt, idx, src, axis=0):
    return tgt.clone().index_add_(axis, idx, src)
def _segment_sum(src, seg, n):
    out = torch.zeros((n,) + src.shape[1:], dtype=src.dtype)
    return out.index_add_(0, seg, src)
def _pad(x, pw):
    flat = tuple(v for pair in reversed(pw) for v in pair)
    return torch.nn.functional.pad(x, flat)

kernel_name = 'parallel_sum__mha_block_cached__dense_activation_silu__decode'

def setup_inputs():

    _w = (lambda a: (lambda t: t.to(torch.bfloat16) if t.is_floating_point() else t)(torch.as_tensor(a)))
    def _A_setup():
        B, Sq, D = 1, 1, 576
        H, Sk, Dh = 32, 32768, 128
        return {
            "x": _w((lambda *s: torch.randn(*s, dtype=torch.bfloat16) * 0.05)(B, Sq, D)),
            "k_cache": _w((lambda *s: torch.randn(*s, dtype=torch.bfloat16) * 3.2)(B, H, Sk, Dh)),
            "v_cache": _w((lambda *s: torch.randn(*s, dtype=torch.bfloat16) * 0.8)(B, H, Sk, Dh)),
            "wq": _w((lambda *s: torch.randn(*s, dtype=torch.bfloat16) * 3.2)(D, H * Dh) * (D ** -0.5)),
            "wo": _w((lambda *s: torch.randn(*s, dtype=torch.bfloat16) * 0.8)(H * Dh, D) * ((H * Dh) ** -0.5)),
        }
    _A_in = _A_setup()

    def _B_setup():
        B, S, D, F = 1, 1, 576, 4608
        return {
            "x": _w((lambda *s: torch.randn(*s, dtype=torch.bfloat16) * 0.05)(B, S, D)),
            "w1": _w((lambda *s: torch.randn(*s, dtype=torch.bfloat16) * 3.2)(D, F) * (D ** -0.5)),
            "w2": _w((lambda *s: torch.randn(*s, dtype=torch.bfloat16) * 0.4)(F, D) * (F ** -0.5)),
        }
    _B_in = _B_setup()

    return {
        "A_x": _A_in["x"],
        "A_k_cache": _A_in["k_cache"],
        "A_v_cache": _A_in["v_cache"],
        "A_wq": _A_in["wq"],
        "A_wo": _A_in["wo"],
        "B_x": _B_in["x"],
        "B_w1": _B_in["w1"],
        "B_w2": _B_in["w2"],
    }

def reference(A_x, A_k_cache, A_v_cache, A_wq, A_wo, B_x, B_w1, B_w2):
    def _A_ref(x, k_cache, v_cache, wq, wo):
        B, Sq, D = x.shape
        H, Dh = 32, 128
        q = (lambda x, *d: x.permute(*d))((x @ wq).reshape(B, Sq, H, Dh), 0, 2, 1, 3)
        scores = torch.einsum("bhqd,bhkd->bhqk", q, k_cache) * (Dh ** -0.5)
        p = _softmax(scores, axis=-1)
        o = torch.einsum("bhqk,bhkd->bhqd", p, v_cache)
        return (lambda x, *d: x.permute(*d))(o, 0, 2, 1, 3).reshape(B, Sq, H * Dh) @ wo

    def _B_ref(x, w1, w2):
        h = torch.einsum("bsd,df->bsf", x, w1)
        h = _silu(h)
        out = torch.einsum("bsf,fd->bsd", h, w2)
        return out

    x = A_x
    xn = _layernorm(x, axis=-1)
    return x + _A_ref(xn, A_k_cache, A_v_cache, A_wq, A_wo) + _B_ref(xn, B_w1, B_w2)
```

```asm
; @launch grid=(256,1,1) block=(256,1,1) lds=26176
.amdgcn_target "amdgcn-amd-amdhsa--gfx950"
.text
.globl parallel_sum__mha_block_cached__dense_activation_silu__decode_kernel
.p2align 8
.type parallel_sum__mha_block_cached__dense_activation_silu__decode_kernel,@function
parallel_sum__mha_block_cached__dense_activation_silu__decode_kernel:
    s_cmp_ge_u32 s2, 256
    s_cbranch_scc1 L_end
    s_load_dwordx16 s[8:23], s[0:1], 0
    s_load_dwordx4 s[24:27], s[0:1], 64
    s_load_dwordx2 s[28:29], s[0:1], 80
    v_and_b32 v1, 63, v0
    v_lshrrev_b32 v3, 6, v0
    v_lshrrev_b32 v44, 4, v1
    v_readfirstlane_b32 s30, v3
    v_and_b32 v45, 15, v1
    v_and_b32 v46, 1, v45
    v_lshlrev_b32 v46, 4, v46
    v_mov_b32 v47, 0xffff
    v_lshlrev_b32 v46, v46, v47
    v_lshrrev_b32 v47, 1, v45
    v_cmp_eq_u32 vcc, 0, v47
    s_nop 1
    v_cndmask_b32 v8, 0, v46, vcc
    v_cmp_eq_u32 vcc, 1, v47
    s_nop 1
    v_cndmask_b32 v9, 0, v46, vcc
    v_cmp_eq_u32 vcc, 2, v47
    s_nop 1
    v_cndmask_b32 v10, 0, v46, vcc
    v_cmp_eq_u32 vcc, 3, v47
    s_nop 1
    v_cndmask_b32 v11, 0, v46, vcc
    s_mov_b32 s80, 0xcccccccc
    s_mov_b32 s81, 0xcccccccc
    s_mov_b32 s82, 0xaaaaaaaa
    s_mov_b32 s83, 0xaaaaaaaa
    s_mov_b32 s86, 0x3db504f3
    s_mov_b32 s87, 0x3fb8aa3b
    s_lshr_b32 s31, s2, 3
    s_add_u32 s4, s2, s31
    s_and_b32 s4, s4, 7
    s_lshl_b32 s5, s31, 3
    s_add_u32 s5, s5, s4
    s_and_b32 s70, s2, 7
    s_and_b32 s69, s31, 3
    s_lshl_b32 s69, s69, 1
    s_cmp_eq_u32 s69, s70
    s_cselect_b32 s74, 1, 0
    s_add_u32 s69, s31, 2
    s_and_b32 s69, s69, 3
    s_lshl_b32 s69, s69, 1
    s_cmp_eq_u32 s69, s70
    s_cselect_b32 s75, 1, 0
    v_lshlrev_b32 v63, 1, v1
    s_mul_i32 s69, s4, 72
    s_lshl_b32 s70, s30, 2
    s_add_u32 s69, s69, s70
    v_lshl_add_u32 v62, v45, 4, v44
    v_add_u32 v62, s69, v62
    v_lshlrev_b32 v62, 1, v62
    v_add_u32 v61, s69, v44
    v_lshlrev_b32 v60, 13, v61
    v_lshl_add_u32 v60, v45, 4, v60
    s_lshl_b32 s69, s31, 8
    v_add_u32 v60, s69, v60
    s_movk_i32 s70, 9216
    v_mul_lo_u32 v58, v61, s70
    v_lshl_add_u32 v58, v45, 4, v58
    s_mul_i32 s69, s31, 288
    v_add_u32 v58, s69, v58
    v_mov_b32 v47, 1073741824
    v_cmp_gt_u32 vcc, 9, v45
    s_nop 1
    v_cndmask_b32 v58, v47, v58, vcc
    s_mul_i32 s69, s30, 4096
    v_lshl_add_u32 v2, v1, 4, s69
    s_mul_i32 s69, s31, 4608
    s_lshl_b32 s70, s4, 9
    s_add_u32 s70, s70, s69
    s_add_u32 s69, s69, 4096
    v_and_b32 v46, 15, v1
    v_lshlrev_b32 v46, 5, v46
    s_add_u32 s71, s70, 1572864
    v_add_u32 v43, s71, v46
    s_add_u32 s71, s69, 1572864
    s_cmp_eq_u32 s74, 1
    s_cselect_b32 s71, s71, 1073741824
    v_add_u32 v57, s71, v46
    v_cmp_eq_u32 vcc, 1, v44
    s_nop 1
    v_cndmask_b32 v43, v43, v57, vcc
    s_add_u32 s71, s70, 1769472
    v_add_u32 v57, s71, v46
    v_cmp_eq_u32 vcc, 2, v44
    s_nop 1
    v_cndmask_b32 v43, v43, v57, vcc
    s_add_u32 s71, s69, 1769472
    s_cmp_eq_u32 s75, 1
    s_cselect_b32 s71, s71, 1073741824
    v_add_u32 v57, s71, v46
    v_cmp_eq_u32 vcc, 3, v44
    s_nop 1
    v_cndmask_b32 v43, v43, v57, vcc
    v_mov_b32 v46, 2031616
    s_mul_i32 s66, s2, 0
    s_and_b32 s66, s66, 63
    s_lshl_b32 s66, s66, 14
    s_mov_b32 s67, 0
    s_waitcnt lgkmcnt(0)
    s_mov_b32 s32, s8
    s_and_b32 s33, s9, 0xffff
    s_mov_b32 s34, 1152
    s_mov_b32 s35, 0x20000
    s_mov_b32 s36, s28
    s_and_b32 s37, s29, 0xffff
    s_mov_b32 s38, 2097152
    s_mov_b32 s39, 0x20000
    s_mov_b32 s52, s14
    s_and_b32 s53, s15, 0xffff
    s_mov_b32 s54, 4718592
    s_mov_b32 s55, 0x20000
    s_mov_b32 s48, s20
    s_and_b32 s49, s21, 0xffff
    s_mov_b32 s50, 5308416
    s_mov_b32 s51, 0x20000
    buffer_load_dword v59, v46, s[36:39], 0 offen sc1
    buffer_load_ushort v48, v63, s[32:35], 0 offen offset:0
    buffer_load_ushort v49, v63, s[32:35], 0 offen offset:128
    buffer_load_ushort v50, v63, s[32:35], 0 offen offset:256
    buffer_load_ushort v51, v63, s[32:35], 0 offen offset:384
    buffer_load_ushort v52, v63, s[32:35], 0 offen offset:512
    buffer_load_ushort v53, v63, s[32:35], 0 offen offset:640
    buffer_load_ushort v54, v63, s[32:35], 0 offen offset:768
    buffer_load_ushort v55, v63, s[32:35], 0 offen offset:896
    buffer_load_ushort v56, v63, s[32:35], 0 offen offset:1024
    buffer_load_ushort v35, v62, s[32:35], 0 offen
    s_cmp_lt_u32 s30, 2
    s_cselect_b32 s84, 524288, 1073741824
    s_cselect_b32 s85, 589824, 1073741824
    s_mov_b32 s69, 0
    buffer_load_dwordx4 v[192:195], v60, s[52:55], s69 offen nt
    s_mov_b32 s69, 131072
    buffer_load_dwordx4 v[196:199], v60, s[52:55], s69 offen nt
    s_mov_b32 s69, 262144
    buffer_load_dwordx4 v[200:203], v60, s[52:55], s69 offen nt
    s_mov_b32 s69, 393216
    buffer_load_dwordx4 v[204:207], v60, s[52:55], s69 offen nt
    buffer_load_dwordx4 v[208:211], v60, s[52:55], s84 offen nt
    s_lshl_b32 s69, s5, 20
    s_add_u32 s44, s10, s69
    s_addc_u32 s45, s11, 0
    s_and_b32 s45, s45, 0xffff
    s_mov_b32 s46, 0x100000
    s_mov_b32 s47, 0x20000
    s_add_u32 s64, s12, s69
    s_addc_u32 s65, s13, 0
    s_and_b32 s65, s65, 0xffff
    s_mul_i32 s69, s31, 147456
    s_add_u32 s56, s16, s69
    s_addc_u32 s57, s17, 0
    s_and_b32 s57, s57, 0xffff
    s_mov_b32 s58, 147456
    s_mov_b32 s59, 0x20000
    s_mul_i32 s69, s31, 165888
    s_add_u32 s76, s22, s69
    s_addc_u32 s77, s23, 0
    s_and_b32 s77, s77, 0xffff
    s_mov_b32 s78, 165888
    s_mov_b32 s79, 0x20000
    s_waitcnt vmcnt(5)
    s_mov_b32 s70, 0
    buffer_load_dwordx4 v[212:215], v58, s[48:51], s70 offen nt
    buffer_load_dwordx4 v[216:219], v58, s[48:51], s70 offen offset:144 nt
    s_mov_b32 s70, 147456
    buffer_load_dwordx4 v[220:223], v58, s[48:51], s70 offen nt
    buffer_load_dwordx4 v[224:227], v58, s[48:51], s70 offen offset:144 nt
    s_mov_b32 s70, 294912
    buffer_load_dwordx4 v[228:231], v58, s[48:51], s70 offen nt
    buffer_load_dwordx4 v[232:235], v58, s[48:51], s70 offen offset:144 nt
    s_mov_b32 s70, 442368
    buffer_load_dwordx4 v[236:239], v58, s[48:51], s70 offen nt
    buffer_load_dwordx4 v[240:243], v58, s[48:51], s70 offen offset:144 nt
    buffer_load_dwordx4 v[244:247], v58, s[48:51], s85 offen nt
    buffer_load_dwordx4 v[248:251], v58, s[48:51], s85 offen offset:144 nt
    v_add_u32 v59, 1, v59
    v_lshlrev_b32 v48, 16, v48
    v_lshlrev_b32 v49, 16, v49
    v_lshlrev_b32 v50, 16, v50
    v_lshlrev_b32 v51, 16, v51
    v_lshlrev_b32 v52, 16, v52
    v_lshlrev_b32 v53, 16, v53
    v_lshlrev_b32 v54, 16, v54
    v_lshlrev_b32 v55, 16, v55
    v_lshlrev_b32 v56, 16, v56
    v_lshlrev_b32 v35, 16, v35
    v_add_f32 v46, v48, v49
    v_add_f32 v46, v46, v50
    v_add_f32 v46, v46, v51
    v_add_f32 v46, v46, v52
    v_add_f32 v46, v46, v53
    v_add_f32 v46, v46, v54
    v_add_f32 v46, v46, v55
    v_add_f32 v46, v46, v56
    s_nop 1
    v_add_f32_dpp v46, v46, v46 row_ror:8 row_mask:0xf bank_mask:0xf
    s_nop 1
    v_add_f32_dpp v46, v46, v46 row_ror:4 row_mask:0xf bank_mask:0xf
    s_nop 1
    v_add_f32_dpp v46, v46, v46 row_ror:2 row_mask:0xf bank_mask:0xf
    s_nop 1
    v_add_f32_dpp v46, v46, v46 row_ror:1 row_mask:0xf bank_mask:0xf
    v_mov_b32 v47, v46
    s_nop 1
    v_permlane16_swap_b32 v46, v47
    v_add_f32 v46, v46, v47
    v_mov_b32 v47, v46
    s_nop 1
    v_permlane32_swap_b32 v46, v47
    v_add_f32 v46, v46, v47
    v_mul_f32 v46, 0x3ae38e39, v46
    v_sub_f32 v47, v48, v46
    v_mul_f32 v57, v47, v47
    v_sub_f32 v47, v49, v46
    v_fmac_f32 v57, v47, v47
    v_sub_f32 v47, v50, v46
    v_fmac_f32 v57, v47, v47
    v_sub_f32 v47, v51, v46
    v_fmac_f32 v57, v47, v47
    v_sub_f32 v47, v52, v46
    v_fmac_f32 v57, v47, v47
    v_sub_f32 v47, v53, v46
    v_fmac_f32 v57, v47, v47
    v_sub_f32 v47, v54, v46
    v_fmac_f32 v57, v47, v47
    v_sub_f32 v47, v55, v46
    v_fmac_f32 v57, v47, v47
    v_sub_f32 v47, v56, v46
    v_fmac_f32 v57, v47, v47
    s_nop 1
    v_add_f32_dpp v57, v57, v57 row_ror:8 row_mask:0xf bank_mask:0xf
    s_nop 1
    v_add_f32_dpp v57, v57, v57 row_ror:4 row_mask:0xf bank_mask:0xf
    s_nop 1
    v_add_f32_dpp v57, v57, v57 row_ror:2 row_mask:0xf bank_mask:0xf
    s_nop 1
    v_add_f32_dpp v57, v57, v57 row_ror:1 row_mask:0xf bank_mask:0xf
    v_mov_b32 v47, v57
    s_nop 1
    v_permlane16_swap_b32 v57, v47
    v_add_f32 v57, v57, v47
    v_mov_b32 v47, v57
    s_nop 1
    v_permlane32_swap_b32 v57, v47
    v_add_f32 v57, v57, v47
    v_mul_f32 v57, 0x3ae38e39, v57
    v_cvt_pk_bf16_f32 v46, 0, v46
    v_cvt_pk_bf16_f32 v57, 0, v57
    v_add_f32 v57, 0x3727c5ac, v57
    v_cvt_pk_bf16_f32 v57, 0, v57
    v_sqrt_f32 v57, v57
    s_nop 0
    v_cvt_pk_bf16_f32 v57, 0, v57
    v_rcp_f32 v61, v57
    v_sub_f32 v47, v35, v46
    v_cvt_pk_bf16_f32 v47, 0, v47
    v_fma_f32 v62, -v57, v61, 1.0
    v_fma_f32 v61, v62, v61, v61
    v_mul_f32 v62, v47, v61
    v_fma_f32 v63, -v62, v57, v47
    v_fma_f32 v62, v63, v61, v62
    v_cvt_pk_bf16_f32 v35, v62, v62
    s_cmp_eq_u32 s67, 64
    s_cselect_b32 s44, s64, s44
    s_cselect_b32 s45, s65, s45
    s_cmp_ge_u32 s67, 128
    s_cselect_b32 s46, 0, s46
    buffer_load_dwordx4 v[64:67], v2, s[44:47], s66 offen offset:0 nt
    buffer_load_dwordx4 v[68:71], v2, s[44:47], s66 offen offset:1024 nt
    buffer_load_dwordx4 v[72:75], v2, s[44:47], s66 offen offset:2048 nt
    buffer_load_dwordx4 v[76:79], v2, s[44:47], s66 offen offset:3072 nt
    s_add_u32 s66, s66, 16384
    s_and_b32 s66, s66, 0xfffff
    s_add_u32 s67, s67, 1
    v_and_b32_dpp v16, v35, v8 row_newbcast:0 row_mask:0xf bank_mask:0xf
    v_and_b32_dpp v17, v35, v9 row_newbcast:0 row_mask:0xf bank_mask:0xf
    v_and_b32_dpp v18, v35, v10 row_newbcast:0 row_mask:0xf bank_mask:0xf
    v_and_b32_dpp v19, v35, v11 row_newbcast:0 row_mask:0xf bank_mask:0xf
    s_waitcnt vmcnt(18)
    s_nop 0
    v_mfma_f32_16x16x32_bf16 v[12:15], v[16:19], v[192:195], 0
    s_waitcnt vmcnt(13)
    v_mfma_f32_16x16x32_bf16 v[24:27], v[16:19], v[212:215], 0
    s_waitcnt vmcnt(12)
    v_mfma_f32_16x16x32_bf16 v[28:31], v[16:19], v[216:219], 0
    v_and_b32_dpp v20, v35, v8 row_newbcast:1 row_mask:0xf bank_mask:0xf
    v_and_b32_dpp v21, v35, v9 row_newbcast:1 row_mask:0xf bank_mask:0xf
    v_and_b32_dpp v22, v35, v10 row_newbcast:1 row_mask:0xf bank_mask:0xf
    v_and_b32_dpp v23, v35, v11 row_newbcast:1 row_mask:0xf bank_mask:0xf
    s_nop 1
    v_mfma_f32_16x16x32_bf16 v[12:15], v[20:23], v[196:199], v[12:15]
    s_waitcnt vmcnt(11)
    v_mfma_f32_16x16x32_bf16 v[24:27], v[20:23], v[220:223], v[24:27]
    s_waitcnt vmcnt(10)
    v_mfma_f32_16x16x32_bf16 v[28:31], v[20:23], v[224:227], v[28:31]
    v_and_b32_dpp v16, v35, v8 row_newbcast:2 row_mask:0xf bank_mask:0xf
    v_and_b32_dpp v17, v35, v9 row_newbcast:2 row_mask:0xf bank_mask:0xf
    v_and_b32_dpp v18, v35, v10 row_newbcast:2 row_mask:0xf bank_mask:0xf
    v_and_b32_dpp v19, v35, v11 row_newbcast:2 row_mask:0xf bank_mask:0xf
    s_nop 1
    v_mfma_f32_16x16x32_bf16 v[12:15], v[16:19], v[200:203], v[12:15]
    s_waitcnt vmcnt(9)
    v_mfma_f32_16x16x32_bf16 v[24:27], v[16:19], v[228:231], v[24:27]
    s_waitcnt vmcnt(8)
    v_mfma_f32_16x16x32_bf16 v[28:31], v[16:19], v[232:235], v[28:31]
    v_and_b32_dpp v20, v35, v8 row_newbcast:3 row_mask:0xf bank_mask:0xf
    v_and_b32_dpp v21, v35, v9 row_newbcast:3 row_mask:0xf bank_mask:0xf
    v_and_b32_dpp v22, v35, v10 row_newbcast:3 row_mask:0xf bank_mask:0xf
    v_and_b32_dpp v23, v35, v11 row_newbcast:3 row_mask:0xf bank_mask:0xf
    s_nop 1
    v_mfma_f32_16x16x32_bf16 v[12:15], v[20:23], v[204:207], v[12:15]
    s_waitcnt vmcnt(7)
    v_mfma_f32_16x16x32_bf16 v[24:27], v[20:23], v[236:239], v[24:27]
    s_waitcnt vmcnt(6)
    v_mfma_f32_16x16x32_bf16 v[28:31], v[20:23], v[240:243], v[28:31]
    v_and_b32_dpp v16, v35, v8 row_newbcast:4 row_mask:0xf bank_mask:0xf
    v_and_b32_dpp v17, v35, v9 row_newbcast:4 row_mask:0xf bank_mask:0xf
    v_and_b32_dpp v18, v35, v10 row_newbcast:4 row_mask:0xf bank_mask:0xf
    v_and_b32_dpp v19, v35, v11 row_newbcast:4 row_mask:0xf bank_mask:0xf
    s_nop 1
    v_mfma_f32_16x16x32_bf16 v[12:15], v[16:19], v[208:211], v[12:15]
    s_waitcnt vmcnt(5)
    v_mfma_f32_16x16x32_bf16 v[24:27], v[16:19], v[244:247], v[24:27]
    s_waitcnt vmcnt(4)
    v_mfma_f32_16x16x32_bf16 v[28:31], v[16:19], v[248:251], v[28:31]
    v_lshlrev_b32 v46, 5, v45
    v_lshl_add_u32 v46, v44, 4, v46
    s_mul_i32 s69, s30, 1088
    v_add_u32 v46, s69, v46
    s_mov_b32 exec_hi, 0
    ds_write_b128 v46, v[12:15] offset:16384
    s_mov_b32 exec_lo, 0x01ff01ff
    ds_write_b128 v46, v[24:27] offset:16896
    ds_write_b128 v46, v[28:31] offset:17184
    s_mov_b64 exec, -1
    s_cmp_eq_u32 s67, 64
    s_cselect_b32 s44, s64, s44
    s_cselect_b32 s45, s65, s45
    s_cmp_ge_u32 s67, 128
    s_cselect_b32 s46, 0, s46
    buffer_load_dwordx4 v[80:83], v2, s[44:47], s66 offen offset:0 nt
    buffer_load_dwordx4 v[84:87], v2, s[44:47], s66 offen offset:1024 nt
    buffer_load_dwordx4 v[88:91], v2, s[44:47], s66 offen offset:2048 nt
    buffer_load_dwordx4 v[92:95], v2, s[44:47], s66 offen offset:3072 nt
    s_add_u32 s66, s66, 16384
    s_and_b32 s66, s66, 0xfffff
    s_add_u32 s67, s67, 1
    s_waitcnt lgkmcnt(0)
    s_barrier
    v_min_u32 v46, 67, v0
    v_lshlrev_b32 v46, 4, v46
    ds_read_b128 v[16:19], v46 offset:16384
    ds_read_b128 v[20:23], v46 offset:17472
    ds_read_b128 v[24:27], v46 offset:18560
    ds_read_b128 v[28:31], v46 offset:19648
    s_lshl_b32 s70, s5, 12
    s_add_u32 s70, s70, 524288
    v_lshl_add_u32 v47, v0, 5, s70
    v_mov_b32 v57, 1073741824
    v_mov_b32 v58, 68
    v_cmp_lt_u32 vcc, v0, v58
    s_nop 1
    v_cndmask_b32 v47, v57, v47, vcc
    s_waitcnt lgkmcnt(0)
    v_add_f32 v16, v16, v20
    v_add_f32 v24, v24, v28
    v_add_f32 v17, v17, v21
    v_add_f32 v25, v25, v29
    v_add_f32 v18, v18, v22
    v_add_f32 v26, v26, v30
    v_add_f32 v19, v19, v23
    v_add_f32 v27, v27, v31
    v_add_f32 v48, v16, v24
    v_mov_b32 v49, v59
    v_add_f32 v50, v17, v25
    v_mov_b32 v51, v59
    v_add_f32 v52, v18, v26
    v_mov_b32 v53, v59
    v_add_f32 v54, v19, v27
    v_mov_b32 v55, v59
    buffer_store_dwordx4 v[48:51], v47, s[36:39], 0 offen sc1
    buffer_store_dwordx4 v[52:55], v47, s[36:39], 0 offen offset:16 sc1
    s_cmp_eq_u32 s67, 64
    s_cselect_b32 s44, s64, s44
    s_cselect_b32 s45, s65, s45
    s_cmp_ge_u32 s67, 128
    s_cselect_b32 s46, 0, s46
    buffer_load_dwordx4 v[96:99], v2, s[44:47], s66 offen offset:0 nt
    buffer_load_dwordx4 v[100:103], v2, s[44:47], s66 offen offset:1024 nt
    buffer_load_dwordx4 v[104:107], v2, s[44:47], s66 offen offset:2048 nt
    buffer_load_dwordx4 v[108:111], v2, s[44:47], s66 offen offset:3072 nt
    s_add_u32 s66, s66, 16384
    s_and_b32 s66, s66, 0xfffff
    s_add_u32 s67, s67, 1
    s_lshl_b32 s69, s31, 15
    s_add_u32 s69, s69, 524288
    v_and_b32 v47, 7, v1
    v_lshlrev_b32 v47, 12, v47
    s_add_u32 s70, s69, 1016
    v_add_u32 v60, s70, v47
    v_lshlrev_b32 v47, 12, v44
    v_lshl_add_u32 v47, v45, 4, v47
    s_lshl_b32 s70, s30, 8
    s_add_u32 s70, s70, s69
    v_add_u32 v58, s70, v47
    buffer_load_dwordx2 v[24:25], v60, s[36:39], 0 offen sc1
    s_cmp_eq_u32 s67, 64
    s_cselect_b32 s44, s64, s44
    s_cselect_b32 s45, s65, s45
    s_cmp_ge_u32 s67, 128
    s_cselect_b32 s46, 0, s46
    buffer_load_dwordx4 v[112:115], v2, s[44:47], s66 offen offset:0 nt
    buffer_load_dwordx4 v[116:119], v2, s[44:47], s66 offen offset:1024 nt
    buffer_load_dwordx4 v[120:123], v2, s[44:47], s66 offen offset:2048 nt
    buffer_load_dwordx4 v[124:127], v2, s[44:47], s66 offen offset:3072 nt
    s_add_u32 s66, s66, 16384
    s_and_b32 s66, s66, 0xfffff
    s_add_u32 s67, s67, 1
    s_waitcnt vmcnt(4)
    v_cmp_ne_u32 vcc, v25, v59
    s_nop 0
    s_cbranch_vccz L_q_from4
    buffer_load_dwordx2 v[24:25], v60, s[36:39], 0 offen sc1
    s_cmp_eq_u32 s67, 64
    s_cselect_b32 s44, s64, s44
    s_cselect_b32 s45, s65, s45
    s_cmp_ge_u32 s67, 128
    s_cselect_b32 s46, 0, s46
    buffer_load_dwordx4 v[128:131], v2, s[44:47], s66 offen offset:0 nt
    buffer_load_dwordx4 v[132:135], v2, s[44:47], s66 offen offset:1024 nt
    buffer_load_dwordx4 v[136:139], v2, s[44:47], s66 offen offset:2048 nt
    buffer_load_dwordx4 v[140:143], v2, s[44:47], s66 offen offset:3072 nt
    s_add_u32 s66, s66, 16384
    s_and_b32 s66, s66, 0xfffff
    s_add_u32 s67, s67, 1
    s_waitcnt vmcnt(4)
    v_cmp_ne_u32 vcc, v25, v59
    s_nop 0
    s_cbranch_vccz L_q_from5
    buffer_load_dwordx2 v[24:25], v60, s[36:39], 0 offen sc1
    s_cmp_eq_u32 s67, 64
    s_cselect_b32 s44, s64, s44
    s_cselect_b32 s45, s65, s45
    s_cmp_ge_u32 s67, 128
    s_cselect_b32 s46, 0, s46
    buffer_load_dwordx4 v[144:147], v2, s[44:47], s66 offen offset:0 nt
    buffer_load_dwordx4 v[148:151], v2, s[44:47], s66 offen offset:1024 nt
    buffer_load_dwordx4 v[152:155], v2, s[44:47], s66 offen offset:2048 nt
    buffer_load_dwordx4 v[156:159], v2, s[44:47], s66 offen offset:3072 nt
    s_add_u32 s66, s66, 16384
    s_and_b32 s66, s66, 0xfffff
    s_add_u32 s67, s67, 1
    s_waitcnt vmcnt(4)
    v_cmp_ne_u32 vcc, v25, v59
    s_nop 0
    s_cbranch_vccz L_q_from6
    buffer_load_dwordx2 v[24:25], v60, s[36:39], 0 offen sc1
    s_cmp_eq_u32 s67, 64
    s_cselect_b32 s44, s64, s44
    s_cselect_b32 s45, s65, s45
    s_cmp_ge_u32 s67, 128
    s_cselect_b32 s46, 0, s46
    buffer_load_dwordx4 v[160:163], v2, s[44:47], s66 offen offset:0 nt
    buffer_load_dwordx4 v[164:167], v2, s[44:47], s66 offen offset:1024 nt
    buffer_load_dwordx4 v[168:171], v2, s[44:47], s66 offen offset:2048 nt
    buffer_load_dwordx4 v[172:175], v2, s[44:47], s66 offen offset:3072 nt
    s_add_u32 s66, s66, 16384
    s_and_b32 s66, s66, 0xfffff
    s_add_u32 s67, s67, 1
    s_waitcnt vmcnt(4)
    v_cmp_ne_u32 vcc, v25, v59
    s_nop 0
    s_cbranch_vccz L_q_from7
    buffer_load_dwordx2 v[24:25], v60, s[36:39], 0 offen sc1
    s_cmp_eq_u32 s67, 64
    s_cselect_b32 s44, s64, s44
    s_cselect_b32 s45, s65, s45
    s_cmp_ge_u32 s67, 128
    s_cselect_b32 s46, 0, s46
    buffer_load_dwordx4 v[176:179], v2, s[44:47], s66 offen offset:0 nt
    buffer_load_dwordx4 v[180:183], v2, s[44:47], s66 offen offset:1024 nt
    buffer_load_dwordx4 v[184:187], v2, s[44:47], s66 offen offset:2048 nt
    buffer_load_dwordx4 v[188:191], v2, s[44:47], s66 offen offset:3072 nt
    s_add_u32 s66, s66, 16384
    s_and_b32 s66, s66, 0xfffff
    s_add_u32 s67, s67, 1
    s_waitcnt vmcnt(4)
    v_cmp_ne_u32 vcc, v25, v59
    s_nop 0
    s_cbranch_vccz L_q_from8
    s_mov_b32 s73, 200000
L_ind:
    buffer_load_dwordx2 v[24:25], v60, s[36:39], 0 offen sc1
    s_waitcnt vmcnt(0)
    v_cmp_ne_u32 vcc, v25, v59
    s_nop 0
    s_cbranch_vccz L_ind_ok
    s_sub_u32 s73, s73, 1
    s_cmp_eq_u32 s73, 0
    s_cbranch_scc1 L_ind_ok
    s_branch L_ind
L_ind_ok:
    s_branch L_q_from8
L_q_from4:
    buffer_load_dwordx4 v[16:19], v58, s[36:39], 0 offen sc1
    s_movk_i32 s69, 16384
    buffer_load_dwordx4 v[20:23], v58, s[36:39], s69 offen sc1
    s_cmp_eq_u32 s67, 64
    s_cselect_b32 s44, s64, s44
    s_cselect_b32 s45, s65, s45
    s_cmp_ge_u32 s67, 128
    s_cselect_b32 s46, 0, s46
    buffer_load_dwordx4 v[128:131], v2, s[44:47], s66 offen offset:0 nt
    buffer_load_dwordx4 v[132:135], v2, s[44:47], s66 offen offset:1024 nt
    buffer_load_dwordx4 v[136:139], v2, s[44:47], s66 offen offset:2048 nt
    buffer_load_dwordx4 v[140:143], v2, s[44:47], s66 offen offset:3072 nt
    s_add_u32 s66, s66, 16384
    s_and_b32 s66, s66, 0xfffff
    s_add_u32 s67, s67, 1
    s_cmp_eq_u32 s67, 64
    s_cselect_b32 s44, s64, s44
    s_cselect_b32 s45, s65, s45
    s_cmp_ge_u32 s67, 128
    s_cselect_b32 s46, 0, s46
    buffer_load_dwordx4 v[144:147], v2, s[44:47], s66 offen offset:0 nt
    buffer_load_dwordx4 v[148:151], v2, s[44:47], s66 offen offset:1024 nt
    buffer_load_dwordx4 v[152:155], v2, s[44:47], s66 offen offset:2048 nt
    buffer_load_dwordx4 v[156:159], v2, s[44:47], s66 offen offset:3072 nt
    s_add_u32 s66, s66, 16384
    s_and_b32 s66, s66, 0xfffff
    s_add_u32 s67, s67, 1
    s_cmp_eq_u32 s67, 64
    s_cselect_b32 s44, s64, s44
    s_cselect_b32 s45, s65, s45
    s_cmp_ge_u32 s67, 128
    s_cselect_b32 s46, 0, s46
    buffer_load_dwordx4 v[160:163], v2, s[44:47], s66 offen offset:0 nt
    buffer_load_dwordx4 v[164:167], v2, s[44:47], s66 offen offset:1024 nt
    buffer_load_dwordx4 v[168:171], v2, s[44:47], s66 offen offset:2048 nt
    buffer_load_dwordx4 v[172:175], v2, s[44:47], s66 offen offset:3072 nt
    s_add_u32 s66, s66, 16384
    s_and_b32 s66, s66, 0xfffff
    s_add_u32 s67, s67, 1
    s_cmp_eq_u32 s67, 64
    s_cselect_b32 s44, s64, s44
    s_cselect_b32 s45, s65, s45
    s_cmp_ge_u32 s67, 128
    s_cselect_b32 s46, 0, s46
    buffer_load_dwordx4 v[176:179], v2, s[44:47], s66 offen offset:0 nt
    buffer_load_dwordx4 v[180:183], v2, s[44:47], s66 offen offset:1024 nt
    buffer_load_dwordx4 v[184:187], v2, s[44:47], s66 offen offset:2048 nt
    buffer_load_dwordx4 v[188:191], v2, s[44:47], s66 offen offset:3072 nt
    s_add_u32 s66, s66, 16384
    s_and_b32 s66, s66, 0xfffff
    s_add_u32 s67, s67, 1
    s_waitcnt vmcnt(16)
    s_branch L_q_chk
L_q_from5:
    buffer_load_dwordx4 v[16:19], v58, s[36:39], 0 offen sc1
    s_movk_i32 s69, 16384
    buffer_load_dwordx4 v[20:23], v58, s[36:39], s69 offen sc1
    s_cmp_eq_u32 s67, 64
    s_cselect_b32 s44, s64, s44
    s_cselect_b32 s45, s65, s45
    s_cmp_ge_u32 s67, 128
    s_cselect_b32 s46, 0, s46
    buffer_load_dwordx4 v[144:147], v2, s[44:47], s66 offen offset:0 nt
    buffer_load_dwordx4 v[148:151], v2, s[44:47], s66 offen offset:1024 nt
    buffer_load_dwordx4 v[152:155], v2, s[44:47], s66 offen offset:2048 nt
    buffer_load_dwordx4 v[156:159], v2, s[44:47], s66 offen offset:3072 nt
    s_add_u32 s66, s66, 16384
    s_and_b32 s66, s66, 0xfffff
    s_add_u32 s67, s67, 1
    s_cmp_eq_u32 s67, 64
    s_cselect_b32 s44, s64, s44
    s_cselect_b32 s45, s65, s45
    s_cmp_ge_u32 s67, 128
    s_cselect_b32 s46, 0, s46
    buffer_load_dwordx4 v[160:163], v2, s[44:47], s66 offen offset:0 nt
    buffer_load_dwordx4 v[164:167], v2, s[44:47], s66 offen offset:1024 nt
    buffer_load_dwordx4 v[168:171], v2, s[44:47], s66 offen offset:2048 nt
    buffer_load_dwordx4 v[172:175], v2, s[44:47], s66 offen offset:3072 nt
    s_add_u32 s66, s66, 16384
    s_and_b32 s66, s66, 0xfffff
    s_add_u32 s67, s67, 1
    s_cmp_eq_u32 s67, 64
    s_cselect_b32 s44, s64, s44
    s_cselect_b32 s45, s65, s45
    s_cmp_ge_u32 s67, 128
    s_cselect_b32 s46, 0, s46
    buffer_load_dwordx4 v[176:179], v2, s[44:47], s66 offen offset:0 nt
    buffer_load_dwordx4 v[180:183], v2, s[44:47], s66 offen offset:1024 nt
    buffer_load_dwordx4 v[184:187], v2, s[44:47], s66 offen offset:2048 nt
    buffer_load_dwordx4 v[188:191], v2, s[44:47], s66 offen offset:3072 nt
    s_add_u32 s66, s66, 16384
    s_and_b32 s66, s66, 0xfffff
    s_add_u32 s67, s67, 1
    s_waitcnt vmcnt(12)
    s_branch L_q_chk
L_q_from6:
    buffer_load_dwordx4 v[16:19], v58, s[36:39], 0 offen sc1
    s_movk_i32 s69, 16384
    buffer_load_dwordx4 v[20:23], v58, s[36:39], s69 offen sc1
    s_cmp_eq_u32 s67, 64
    s_cselect_b32 s44, s64, s44
    s_cselect_b32 s45, s65, s45
    s_cmp_ge_u32 s67, 128
    s_cselect_b32 s46, 0, s46
    buffer_load_dwordx4 v[160:163], v2, s[44:47], s66 offen offset:0 nt
    buffer_load_dwordx4 v[164:167], v2, s[44:47], s66 offen offset:1024 nt
    buffer_load_dwordx4 v[168:171], v2, s[44:47], s66 offen offset:2048 nt
    buffer_load_dwordx4 v[172:175], v2, s[44:47], s66 offen offset:3072 nt
    s_add_u32 s66, s66, 16384
    s_and_b32 s66, s66, 0xfffff
    s_add_u32 s67, s67, 1
    s_cmp_eq_u32 s67, 64
    s_cselect_b32 s44, s64, s44
    s_cselect_b32 s45, s65, s45
    s_cmp_ge_u32 s67, 128
    s_cselect_b32 s46, 0, s46
    buffer_load_dwordx4 v[176:179], v2, s[44:47], s66 offen offset:0 nt
    buffer_load_dwordx4 v[180:183], v2, s[44:47], s66 offen offset:1024 nt
    buffer_load_dwordx4 v[184:187], v2, s[44:47], s66 offen offset:2048 nt
    buffer_load_dwordx4 v[188:191], v2, s[44:47], s66 offen offset:3072 nt
    s_add_u32 s66, s66, 16384
    s_and_b32 s66, s66, 0xfffff
    s_add_u32 s67, s67, 1
    s_waitcnt vmcnt(8)
    s_branch L_q_chk
L_q_from7:
    buffer_load_dwordx4 v[16:19], v58, s[36:39], 0 offen sc1
    s_movk_i32 s69, 16384
    buffer_load_dwordx4 v[20:23], v58, s[36:39], s69 offen sc1
    s_cmp_eq_u32 s67, 64
    s_cselect_b32 s44, s64, s44
    s_cselect_b32 s45, s65, s45
    s_cmp_ge_u32 s67, 128
    s_cselect_b32 s46, 0, s46
    buffer_load_dwordx4 v[176:179], v2, s[44:47], s66 offen offset:0 nt
    buffer_load_dwordx4 v[180:183], v2, s[44:47], s66 offen offset:1024 nt
    buffer_load_dwordx4 v[184:187], v2, s[44:47], s66 offen offset:2048 nt
    buffer_load_dwordx4 v[188:191], v2, s[44:47], s66 offen offset:3072 nt
    s_add_u32 s66, s66, 16384
    s_and_b32 s66, s66, 0xfffff
    s_add_u32 s67, s67, 1
    s_waitcnt vmcnt(4)
    s_branch L_q_chk
L_q_from8:
    buffer_load_dwordx4 v[16:19], v58, s[36:39], 0 offen sc1
    s_movk_i32 s69, 16384
    buffer_load_dwordx4 v[20:23], v58, s[36:39], s69 offen sc1
    s_waitcnt vmcnt(0)
L_q_chk:
    s_mov_b32 s73, 200000
    s_branch L_q_t
L_q:
    buffer_load_dwordx4 v[16:19], v58, s[36:39], 0 offen sc1
    s_movk_i32 s69, 16384
    buffer_load_dwordx4 v[20:23], v58, s[36:39], s69 offen sc1
    s_waitcnt vmcnt(0)
L_q_t:
    v_min3_u32 v61, v17, v19, v59
    v_min3_u32 v61, v61, v21, v23
    v_max3_u32 v62, v17, v19, v59
    v_max3_u32 v62, v62, v21, v23
    v_cmp_ne_u32 vcc, v61, v62
    s_nop 0
    s_cbranch_vccz L_q_ok
    s_sub_u32 s73, s73, 1
    s_cmp_eq_u32 s73, 0
    s_cbranch_scc1 L_q_ok
    s_branch L_q
L_q_ok:
    v_add_f32 v16, v16, v20
    v_add_f32 v18, v18, v22
    v_mov_b32 v26, v16
    s_nop 1
    v_permlane16_swap_b32 v16, v26
    v_add_f32 v16, v16, v26
    v_mov_b32 v26, v16
    s_nop 1
    v_permlane32_swap_b32 v16, v26
    v_add_f32 v16, v16, v26
    v_mov_b32 v26, v18
    s_nop 1
    v_permlane16_swap_b32 v18, v26
    v_add_f32 v18, v18, v26
    v_mov_b32 v26, v18
    s_nop 1
    v_permlane32_swap_b32 v18, v26
    v_add_f32 v18, v18, v26
    v_cvt_pk_bf16_f32 v16, v16, v18
    v_lshlrev_b32 v46, 2, v45
    s_lshl_b32 s69, s30, 6
    v_add_u32 v46, s69, v46
    ds_write_b32 v46, v16 offset:20736
    s_lshl_b32 s69, s4, 7
    v_lshl_add_u32 v46, v45, 4, s69
    s_cmp_eq_u32 s75, 1
    s_cselect_b32 s69, 896, 1073741824
    v_lshl_add_u32 v47, v45, 4, s69
    v_cmp_gt_u32 vcc, 8, v45
    s_nop 1
    v_cndmask_b32 v46, v47, v46, vcc
    s_mul_i32 s69, s30, 41472
    v_mul_u32_u24 v47, 1152, v44
    v_add3_u32 v46, v46, v47, s69
    s_mov_b32 s69, 0
    buffer_load_dwordx4 v[192:195], v46, s[76:79], s69 offen nt
    s_mov_b32 s69, 4608
    buffer_load_dwordx4 v[196:199], v46, s[76:79], s69 offen nt
    s_mov_b32 s69, 9216
    buffer_load_dwordx4 v[200:203], v46, s[76:79], s69 offen nt
    s_mov_b32 s69, 13824
    buffer_load_dwordx4 v[204:207], v46, s[76:79], s69 offen nt
    s_mov_b32 s69, 18432
    buffer_load_dwordx4 v[208:211], v46, s[76:79], s69 offen nt
    s_mov_b32 s69, 23040
    buffer_load_dwordx4 v[212:215], v46, s[76:79], s69 offen nt
    s_mov_b32 s69, 27648
    buffer_load_dwordx4 v[216:219], v46, s[76:79], s69 offen nt
    s_mov_b32 s69, 32256
    buffer_load_dwordx4 v[220:223], v46, s[76:79], s69 offen nt
    s_mov_b32 s69, 36864
    buffer_load_dwordx4 v[224:227], v46, s[76:79], s69 offen nt
    s_lshl_b32 s69, s30, 6
    v_add_u32 v47, s69, v1
    v_min_u32 v47, 143, v47
    s_lshl_b32 s69, s31, 15
    s_add_u32 s69, s69, 525312
    v_lshl_add_u32 v60, v47, 3, s69
    s_mov_b32 s69, 0
    buffer_load_dwordx2 v[228:229], v60, s[36:39], s69 offen sc1
    s_mov_b32 s69, 4096
    buffer_load_dwordx2 v[230:231], v60, s[36:39], s69 offen sc1
    s_mov_b32 s69, 8192
    buffer_load_dwordx2 v[232:233], v60, s[36:39], s69 offen sc1
    s_mov_b32 s69, 12288
    buffer_load_dwordx2 v[234:235], v60, s[36:39], s69 offen sc1
    s_mov_b32 s69, 16384
    buffer_load_dwordx2 v[236:237], v60, s[36:39], s69 offen sc1
    s_mov_b32 s69, 20480
    buffer_load_dwordx2 v[238:239], v60, s[36:39], s69 offen sc1
    s_mov_b32 s69, 24576
    buffer_load_dwordx2 v[240:241], v60, s[36:39], s69 offen sc1
    s_mov_b32 s69, 28672
    buffer_load_dwordx2 v[242:243], v60, s[36:39], s69 offen sc1
    s_waitcnt lgkmcnt(0)
    s_barrier
    v_lshlrev_b32 v46, 4, v45
    ds_read_b128 v[4:7], v46 offset:20736
    s_mul_i32 s69, s30, 4096
    v_lshl_add_u32 v42, v1, 2, s69
    v_mov_b32 v37, 0xff800000
    s_waitcnt lgkmcnt(0)
    s_waitcnt vmcnt(45)
    v_dot2_f32_bf16 v24, v64, v4, 0
    v_dot2_f32_bf16 v25, v68, v4, 0
    v_dot2_f32_bf16 v24, v65, v5, v24
    v_dot2_f32_bf16 v25, v69, v5, v25
    v_dot2_f32_bf16 v24, v66, v6, v24
    v_dot2_f32_bf16 v25, v70, v6, v25
    v_dot2_f32_bf16 v24, v67, v7, v24
    v_dot2_f32_bf16 v25, v71, v7, v25
    s_cmp_eq_u32 s67, 64
    s_cselect_b32 s44, s64, s44
    s_cselect_b32 s45, s65, s45
    s_cmp_ge_u32 s67, 128
    s_cselect_b32 s46, 0, s46
    buffer_load_dwordx4 v[64:67], v2, s[44:47], s66 offen offset:0 nt
    buffer_load_dwordx4 v[68:71], v2, s[44:47], s66 offen offset:1024 nt
    v_add_f32_dpp v28, v24, v24 row_ror:8 row_mask:0xf bank_mask:0x3
    s_nop 1
    v_add_f32_dpp v28, v25, v25 row_ror:8 row_mask:0xf bank_mask:0xc
    v_dot2_f32_bf16 v26, v72, v4, 0
    v_dot2_f32_bf16 v27, v76, v4, 0
    v_dot2_f32_bf16 v26, v73, v5, v26
    v_dot2_f32_bf16 v27, v77, v5, v27
    v_dot2_f32_bf16 v26, v74, v6, v26
    v_dot2_f32_bf16 v27, v78, v6, v27
    v_dot2_f32_bf16 v26, v75, v7, v26
    v_dot2_f32_bf16 v27, v79, v7, v27
    buffer_load_dwordx4 v[72:75], v2, s[44:47], s66 offen offset:2048 nt
    buffer_load_dwordx4 v[76:79], v2, s[44:47], s66 offen offset:3072 nt
    s_add_u32 s66, s66, 16384
    s_and_b32 s66, s66, 0xfffff
    s_add_u32 s67, s67, 1
    v_add_f32_dpp v29, v26, v26 row_ror:8 row_mask:0xf bank_mask:0x3
    s_nop 1
    v_add_f32_dpp v29, v27, v27 row_ror:8 row_mask:0xf bank_mask:0xc
    v_add_f32_dpp v30, v28, v28 row_half_mirror row_mask:0xf bank_mask:0x5
    s_nop 1
    v_add_f32_dpp v30, v29, v29 row_half_mirror row_mask:0xf bank_mask:0xa
    s_waitcnt vmcnt(45)
    v_dot2_f32_bf16 v24, v80, v4, 0
    v_dot2_f32_bf16 v25, v84, v4, 0
    v_dot2_f32_bf16 v24, v81, v5, v24
    v_dot2_f32_bf16 v25, v85, v5, v25
    v_dot2_f32_bf16 v24, v82, v6, v24
    v_dot2_f32_bf16 v25, v86, v6, v25
    v_dot2_f32_bf16 v24, v83, v7, v24
    v_dot2_f32_bf16 v25, v87, v7, v25
    s_cmp_eq_u32 s67, 64
    s_cselect_b32 s44, s64, s44
    s_cselect_b32 s45, s65, s45
    s_cmp_ge_u32 s67, 128
    s_cselect_b32 s46, 0, s46
    buffer_load_dwordx4 v[80:83], v2, s[44:47], s66 offen offset:0 nt
    buffer_load_dwordx4 v[84:87], v2, s[44:47], s66 offen offset:1024 nt
    v_add_f32_dpp v28, v24, v24 row_ror:8 row_mask:0xf bank_mask:0x3
    s_nop 1
    v_add_f32_dpp v28, v25, v25 row_ror:8 row_mask:0xf bank_mask:0xc
    v_dot2_f32_bf16 v26, v88, v4, 0
    v_dot2_f32_bf16 v27, v92, v4, 0
    v_dot2_f32_bf16 v26, v89, v5, v26
    v_dot2_f32_bf16 v27, v93, v5, v27
    v_dot2_f32_bf16 v26, v90, v6, v26
    v_dot2_f32_bf16 v27, v94, v6, v27
    v_dot2_f32_bf16 v26, v91, v7, v26
    v_dot2_f32_bf16 v27, v95, v7, v27
    s_nop 1
    v_add_f32_dpp v29, v26, v26 row_ror:8 row_mask:0xf bank_mask:0x3
    s_nop 1
    v_add_f32_dpp v29, v27, v27 row_ror:8 row_mask:0xf bank_mask:0xc
    v_add_f32_dpp v31, v28, v28 row_half_mirror row_mask:0xf bank_mask:0x5
    s_nop 1
    v_add_f32_dpp v31, v29, v29 row_half_mirror row_mask:0xf bank_mask:0xa
    s_waitcnt vmcnt(43)
    v_dot2_f32_bf16 v24, v96, v4, 0
    v_dot2_f32_bf16 v25, v100, v4, 0
    v_dot2_f32_bf16 v24, v97, v5, v24
    v_dot2_f32_bf16 v25, v101, v5, v25
    v_dot2_f32_bf16 v24, v98, v6, v24
    v_dot2_f32_bf16 v25, v102, v6, v25
    v_dot2_f32_bf16 v24, v99, v7, v24
    v_dot2_f32_bf16 v25, v103, v7, v25
    s_nop 1
    v_add_f32_dpp v28, v24, v24 row_ror:8 row_mask:0xf bank_mask:0x3
    s_nop 1
    v_add_f32_dpp v28, v25, v25 row_ror:8 row_mask:0xf bank_mask:0xc
    v_dot2_f32_bf16 v26, v104, v4, 0
    v_dot2_f32_bf16 v27, v108, v4, 0
    v_dot2_f32_bf16 v26, v105, v5, v26
    v_dot2_f32_bf16 v27, v109, v5, v27
    v_dot2_f32_bf16 v26, v106, v6, v26
    v_dot2_f32_bf16 v27, v110, v6, v27
    v_dot2_f32_bf16 v26, v107, v7, v26
    v_dot2_f32_bf16 v27, v111, v7, v27
    s_nop 1
    v_add_f32_dpp v29, v26, v26 row_ror:8 row_mask:0xf bank_mask:0x3
    s_nop 1
    v_add_f32_dpp v29, v27, v27 row_ror:8 row_mask:0xf bank_mask:0xc
    v_add_f32_dpp v32, v28, v28 row_half_mirror row_mask:0xf bank_mask:0x5
    s_nop 1
    v_add_f32_dpp v32, v29, v29 row_half_mirror row_mask:0xf bank_mask:0xa
    s_waitcnt vmcnt(39)
    v_dot2_f32_bf16 v24, v112, v4, 0
    v_dot2_f32_bf16 v25, v116, v4, 0
    v_dot2_f32_bf16 v24, v113, v5, v24
    v_dot2_f32_bf16 v25, v117, v5, v25
    v_dot2_f32_bf16 v24, v114, v6, v24
    v_dot2_f32_bf16 v25, v118, v6, v25
    v_dot2_f32_bf16 v24, v115, v7, v24
    v_dot2_f32_bf16 v25, v119, v7, v25
    s_nop 1
    v_add_f32_dpp v28, v24, v24 row_ror:8 row_mask:0xf bank_mask:0x3
    s_nop 1
    v_add_f32_dpp v28, v25, v25 row_ror:8 row_mask:0xf bank_mask:0xc
    v_dot2_f32_bf16 v26, v120, v4, 0
    v_dot2_f32_bf16 v27, v124, v4, 0
    v_dot2_f32_bf16 v26, v121, v5, v26
    v_dot2_f32_bf16 v27, v125, v5, v27
    v_dot2_f32_bf16 v26, v122, v6, v26
    v_dot2_f32_bf16 v27, v126, v6, v27
    v_dot2_f32_bf16 v26, v123, v7, v26
    v_dot2_f32_bf16 v27, v127, v7, v27
    s_nop 1
    v_add_f32_dpp v29, v26, v26 row_ror:8 row_mask:0xf bank_mask:0x3
    s_nop 1
    v_add_f32_dpp v29, v27, v27 row_ror:8 row_mask:0xf bank_mask:0xc
    v_add_f32_dpp v33, v28, v28 row_half_mirror row_mask:0xf bank_mask:0x5
    s_nop 1
    v_add_f32_dpp v33, v29, v29 row_half_mirror row_mask:0xf bank_mask:0xa
    v_add_f32_dpp v24, v30, v30 quad_perm:[2,3,0,1] row_mask:0xf bank_mask:0xf
    v_add_f32_dpp v25, v31, v31 quad_perm:[2,3,0,1] row_mask:0xf bank_mask:0xf
    v_add_f32_dpp v26, v32, v32 quad_perm:[2,3,0,1] row_mask:0xf bank_mask:0xf
    v_add_f32_dpp v27, v33, v33 quad_perm:[2,3,0,1] row_mask:0xf bank_mask:0xf
    v_cndmask_b32 v34, v24, v25, s[80:81]
    v_cndmask_b32 v46, v26, v27, s[80:81]
    s_nop 0
    v_add_f32_dpp v28, v34, v34 quad_perm:[1,0,3,2] row_mask:0xf bank_mask:0xf
    v_add_f32_dpp v29, v46, v46 quad_perm:[1,0,3,2] row_mask:0xf bank_mask:0xf
    v_cndmask_b32 v36, v28, v29, s[82:83]
    v_cvt_pk_bf16_f32 v36, 0, v36
    v_mul_f32 v36, s86, v36
    v_cvt_pk_bf16_f32 v36, 0, v36
    v_max_f32 v37, v37, v36
    ds_write_b32 v42, v36 offset:0
    v_add_u32 v42, 256, v42
    s_waitcnt vmcnt(35)
    v_dot2_f32_bf16 v24, v128, v4, 0
    v_dot2_f32_bf16 v25, v132, v4, 0
    v_dot2_f32_bf16 v24, v129, v5, v24
    v_dot2_f32_bf16 v25, v133, v5, v25
    v_dot2_f32_bf16 v24, v130, v6, v24
    v_dot2_f32_bf16 v25, v134, v6, v25
    v_dot2_f32_bf16 v24, v131, v7, v24
    v_dot2_f32_bf16 v25, v135, v7, v25
    s_nop 1
    v_add_f32_dpp v28, v24, v24 row_ror:8 row_mask:0xf bank_mask:0x3
    s_nop 1
    v_add_f32_dpp v28, v25, v25 row_ror:8 row_mask:0xf bank_mask:0xc
    v_dot2_f32_bf16 v26, v136, v4, 0
    v_dot2_f32_bf16 v27, v140, v4, 0
    v_dot2_f32_bf16 v26, v137, v5, v26
    v_dot2_f32_bf16 v27, v141, v5, v27
    v_dot2_f32_bf16 v26, v138, v6, v26
    v_dot2_f32_bf16 v27, v142, v6, v27
    v_dot2_f32_bf16 v26, v139, v7, v26
    v_dot2_f32_bf16 v27, v143, v7, v27
    s_nop 1
    v_add_f32_dpp v29, v26, v26 row_ror:8 row_mask:0xf bank_mask:0x3
    s_nop 1
    v_add_f32_dpp v29, v27, v27 row_ror:8 row_mask:0xf bank_mask:0xc
    v_add_f32_dpp v30, v28, v28 row_half_mirror row_mask:0xf bank_mask:0x5
    s_nop 1
    v_add_f32_dpp v30, v29, v29 row_half_mirror row_mask:0xf bank_mask:0xa
    s_waitcnt vmcnt(31)
    v_dot2_f32_bf16 v24, v144, v4, 0
    v_dot2_f32_bf16 v25, v148, v4, 0
    v_dot2_f32_bf16 v24, v145, v5, v24
    v_dot2_f32_bf16 v25, v149, v5, v25
    v_dot2_f32_bf16 v24, v146, v6, v24
    v_dot2_f32_bf16 v25, v150, v6, v25
    v_dot2_f32_bf16 v24, v147, v7, v24
    v_dot2_f32_bf16 v25, v151, v7, v25
    s_nop 1
    v_add_f32_dpp v28, v24, v24 row_ror:8 row_mask:0xf bank_mask:0x3
    s_nop 1
    v_add_f32_dpp v28, v25, v25 row_ror:8 row_mask:0xf bank_mask:0xc
    v_dot2_f32_bf16 v26, v152, v4, 0
    v_dot2_f32_bf16 v27, v156, v4, 0
    v_dot2_f32_bf16 v26, v153, v5, v26
    v_dot2_f32_bf16 v27, v157, v5, v27
    v_dot2_f32_bf16 v26, v154, v6, v26
    v_dot2_f32_bf16 v27, v158, v6, v27
    v_dot2_f32_bf16 v26, v155, v7, v26
    v_dot2_f32_bf16 v27, v159, v7, v27
    s_nop 1
    v_add_f32_dpp v29, v26, v26 row_ror:8 row_mask:0xf bank_mask:0x3
    s_nop 1
    v_add_f32_dpp v29, v27, v27 row_ror:8 row_mask:0xf bank_mask:0xc
    v_add_f32_dpp v31, v28, v28 row_half_mirror row_mask:0xf bank_mask:0x5
    s_nop 1
    v_add_f32_dpp v31, v29, v29 row_half_mirror row_mask:0xf bank_mask:0xa
    s_waitcnt vmcnt(27)
    v_dot2_f32_bf16 v24, v160, v4, 0
    v_dot2_f32_bf16 v25, v164, v4, 0
    v_dot2_f32_bf16 v24, v161, v5, v24
    v_dot2_f32_bf16 v25, v165, v5, v25
    v_dot2_f32_bf16 v24, v162, v6, v24
    v_dot2_f32_bf16 v25, v166, v6, v25
    v_dot2_f32_bf16 v24, v163, v7, v24
    v_dot2_f32_bf16 v25, v167, v7, v25
    s_nop 1
    v_add_f32_dpp v28, v24, v24 row_ror:8 row_mask:0xf bank_mask:0x3
    s_nop 1
    v_add_f32_dpp v28, v25, v25 row_ror:8 row_mask:0xf bank_mask:0xc
    v_dot2_f32_bf16 v26, v168, v4, 0
    v_dot2_f32_bf16 v27, v172, v4, 0
    v_dot2_f32_bf16 v26, v169, v5, v26
    v_dot2_f32_bf16 v27, v173, v5, v27
    v_dot2_f32_bf16 v26, v170, v6, v26
    v_dot2_f32_bf16 v27, v174, v6, v27
    v_dot2_f32_bf16 v26, v171, v7, v26
    v_dot2_f32_bf16 v27, v175, v7, v27
    s_nop 1
    v_add_f32_dpp v29, v26, v26 row_ror:8 row_mask:0xf bank_mask:0x3
    s_nop 1
    v_add_f32_dpp v29, v27, v27 row_ror:8 row_mask:0xf bank_mask:0xc
    v_add_f32_dpp v32, v28, v28 row_half_mirror row_mask:0xf bank_mask:0x5
    s_nop 1
    v_add_f32_dpp v32, v29, v29 row_half_mirror row_mask:0xf bank_mask:0xa
    s_waitcnt vmcnt(23)
    v_dot2_f32_bf16 v24, v176, v4, 0
    v_dot2_f32_bf16 v25, v180, v4, 0
    v_dot2_f32_bf16 v24, v177, v5, v24
    v_dot2_f32_bf16 v25, v181, v5, v25
    v_dot2_f32_bf16 v24, v178, v6, v24
    v_dot2_f32_bf16 v25, v182, v6, v25
    v_dot2_f32_bf16 v24, v179, v7, v24
    v_dot2_f32_bf16 v25, v183, v7, v25
    s_nop 1
    v_add_f32_dpp v28, v24, v24 row_ror:8 row_mask:0xf bank_mask:0x3
    s_nop 1
    v_add_f32_dpp v28, v25, v25 row_ror:8 row_mask:0xf bank_mask:0xc
    v_dot2_f32_bf16 v26, v184, v4, 0
    v_dot2_f32_bf16 v27, v188, v4, 0
    v_dot2_f32_bf16 v26, v185, v5, v26
    v_dot2_f32_bf16 v27, v189, v5, v27
    v_dot2_f32_bf16 v26, v186, v6, v26
    v_dot2_f32_bf16 v27, v190, v6, v27
    v_dot2_f32_bf16 v26, v187, v7, v26
    v_dot2_f32_bf16 v27, v191, v7, v27
    s_nop 1
    v_add_f32_dpp v29, v26, v26 row_ror:8 row_mask:0xf bank_mask:0x3
    s_nop 1
    v_add_f32_dpp v29, v27, v27 row_ror:8 row_mask:0xf bank_mask:0xc
    v_add_f32_dpp v33, v28, v28 row_half_mirror row_mask:0xf bank_mask:0x5
    s_nop 1
    v_add_f32_dpp v33, v29, v29 row_half_mirror row_mask:0xf bank_mask:0xa
    v_add_f32_dpp v24, v30, v30 quad_perm:[2,3,0,1] row_mask:0xf bank_mask:0xf
    v_add_f32_dpp v25, v31, v31 quad_perm:[2,3,0,1] row_mask:0xf bank_mask:0xf
    v_add_f32_dpp v26, v32, v32 quad_perm:[2,3,0,1] row_mask:0xf bank_mask:0xf
    v_add_f32_dpp v27, v33, v33 quad_perm:[2,3,0,1] row_mask:0xf bank_mask:0xf
    v_cndmask_b32 v34, v24, v25, s[80:81]
    v_cndmask_b32 v46, v26, v27, s[80:81]
    s_nop 0
    v_add_f32_dpp v28, v34, v34 quad_perm:[1,0,3,2] row_mask:0xf bank_mask:0xf
    v_add_f32_dpp v29, v46, v46 quad_perm:[1,0,3,2] row_mask:0xf bank_mask:0xf
    v_cndmask_b32 v36, v28, v29, s[82:83]
    v_cvt_pk_bf16_f32 v36, 0, v36
    v_mul_f32 v36, s86, v36
    v_cvt_pk_bf16_f32 v36, 0, v36
    v_max_f32 v37, v37, v36
    ds_write_b32 v42, v36 offset:0
    v_add_u32 v42, 256, v42
    s_waitcnt vmcnt(6)
    s_mov_b32 s73, 200000
    s_branch L_fg_t
L_fg:
    s_mov_b32 s69, 0
    buffer_load_dwordx2 v[228:229], v60, s[36:39], s69 offen sc1
    s_mov_b32 s69, 4096
    buffer_load_dwordx2 v[230:231], v60, s[36:39], s69 offen sc1
    s_mov_b32 s69, 8192
    buffer_load_dwordx2 v[232:233], v60, s[36:39], s69 offen sc1
    s_mov_b32 s69, 12288
    buffer_load_dwordx2 v[234:235], v60, s[36:39], s69 offen sc1
    s_mov_b32 s69, 16384
    buffer_load_dwordx2 v[236:237], v60, s[36:39], s69 offen sc1
    s_mov_b32 s69, 20480
    buffer_load_dwordx2 v[238:239], v60, s[36:39], s69 offen sc1
    s_mov_b32 s69, 24576
    buffer_load_dwordx2 v[240:241], v60, s[36:39], s69 offen sc1
    s_mov_b32 s69, 28672
    buffer_load_dwordx2 v[242:243], v60, s[36:39], s69 offen sc1
    s_waitcnt vmcnt(0)
L_fg_t:
    v_min3_u32 v61, v229, v231, v59
    v_min3_u32 v61, v61, v233, v235
    v_min3_u32 v61, v61, v237, v239
    v_min3_u32 v61, v61, v241, v243
    v_max3_u32 v62, v229, v231, v59
    v_max3_u32 v62, v62, v233, v235
    v_max3_u32 v62, v62, v237, v239
    v_max3_u32 v62, v62, v241, v243
    v_cmp_ne_u32 vcc, v61, v62
    s_nop 0
    s_cbranch_vccz L_fg_ok
    s_sub_u32 s73, s73, 1
    s_cmp_eq_u32 s73, 0
    s_cbranch_scc1 L_fg_ok
    s_branch L_fg
L_fg_ok:
    v_add_f32 v228, v228, v230
    v_add_f32 v228, v228, v232
    v_add_f32 v228, v228, v234
    v_add_f32 v228, v228, v236
    v_add_f32 v228, v228, v238
    v_add_f32 v228, v228, v240
    v_add_f32 v228, v228, v242
    v_cvt_pk_bf16_f32 v16, 0, v228
    v_mul_f32 v18, s87, v16
    v_sub_f32 v18, 0, v18
    v_exp_f32 v18, v18
    s_nop 0
    v_add_f32 v18, 1.0, v18
    v_rcp_f32 v18, v18
    s_nop 0
    v_mul_f32 v16, v16, v18
    v_cvt_pk_bf16_f32 v16, v16, v16
    s_lshl_b32 s69, s30, 8
    v_lshl_add_u32 v46, v1, 2, s69
    ds_write_b32 v46, v16 offset:20992
    s_waitcnt lgkmcnt(0)
    s_barrier
    v_lshlrev_b32 v46, 4, v45
    v_lshl_add_u32 v46, v44, 2, v46
    s_mul_i32 s69, s30, 144
    v_add_u32 v46, s69, v46
    ds_read_b32 v40, v46 offset:20992
    s_waitcnt lgkmcnt(0)
    v_and_b32_dpp v16, v40, v8 row_newbcast:0 row_mask:0xf bank_mask:0xf
    v_and_b32_dpp v17, v40, v9 row_newbcast:0 row_mask:0xf bank_mask:0xf
    v_and_b32_dpp v18, v40, v10 row_newbcast:0 row_mask:0xf bank_mask:0xf
    v_and_b32_dpp v19, v40, v11 row_newbcast:0 row_mask:0xf bank_mask:0xf
    s_nop 1
    v_mfma_f32_16x16x32_bf16 v[12:15], v[16:19], v[192:195], 0
    v_and_b32_dpp v20, v40, v8 row_newbcast:1 row_mask:0xf bank_mask:0xf
    v_and_b32_dpp v21, v40, v9 row_newbcast:1 row_mask:0xf bank_mask:0xf
    v_and_b32_dpp v22, v40, v10 row_newbcast:1 row_mask:0xf bank_mask:0xf
    v_and_b32_dpp v23, v40, v11 row_newbcast:1 row_mask:0xf bank_mask:0xf
    s_nop 1
    v_mfma_f32_16x16x32_bf16 v[12:15], v[20:23], v[196:199], v[12:15]
    v_and_b32_dpp v16, v40, v8 row_newbcast:2 row_mask:0xf bank_mask:0xf
    v_and_b32_dpp v17, v40, v9 row_newbcast:2 row_mask:0xf bank_mask:0xf
    v_and_b32_dpp v18, v40, v10 row_newbcast:2 row_mask:0xf bank_mask:0xf
    v_and_b32_dpp v19, v40, v11 row_newbcast:2 row_mask:0xf bank_mask:0xf
    s_nop 1
    v_mfma_f32_16x16x32_bf16 v[12:15], v[16:19], v[200:203], v[12:15]
    v_and_b32_dpp v20, v40, v8 row_newbcast:3 row_mask:0xf bank_mask:0xf
    v_and_b32_dpp v21, v40, v9 row_newbcast:3 row_mask:0xf bank_mask:0xf
    v_and_b32_dpp v22, v40, v10 row_newbcast:3 row_mask:0xf bank_mask:0xf
    v_and_b32_dpp v23, v40, v11 row_newbcast:3 row_mask:0xf bank_mask:0xf
    s_nop 1
    v_mfma_f32_16x16x32_bf16 v[12:15], v[20:23], v[204:207], v[12:15]
    v_and_b32_dpp v16, v40, v8 row_newbcast:4 row_mask:0xf bank_mask:0xf
    v_and_b32_dpp v17, v40, v9 row_newbcast:4 row_mask:0xf bank_mask:0xf
    v_and_b32_dpp v18, v40, v10 row_newbcast:4 row_mask:0xf bank_mask:0xf
    v_and_b32_dpp v19, v40, v11 row_newbcast:4 row_mask:0xf bank_mask:0xf
    s_nop 1
    v_mfma_f32_16x16x32_bf16 v[12:15], v[16:19], v[208:211], v[12:15]
    v_and_b32_dpp v20, v40, v8 row_newbcast:5 row_mask:0xf bank_mask:0xf
    v_and_b32_dpp v21, v40, v9 row_newbcast:5 row_mask:0xf bank_mask:0xf
    v_and_b32_dpp v22, v40, v10 row_newbcast:5 row_mask:0xf bank_mask:0xf
    v_and_b32_dpp v23, v40, v11 row_newbcast:5 row_mask:0xf bank_mask:0xf
    s_nop 1
    v_mfma_f32_16x16x32_bf16 v[12:15], v[20:23], v[212:215], v[12:15]
    v_and_b32_dpp v16, v40, v8 row_newbcast:6 row_mask:0xf bank_mask:0xf
    v_and_b32_dpp v17, v40, v9 row_newbcast:6 row_mask:0xf bank_mask:0xf
    v_and_b32_dpp v18, v40, v10 row_newbcast:6 row_mask:0xf bank_mask:0xf
    v_and_b32_dpp v19, v40, v11 row_newbcast:6 row_mask:0xf bank_mask:0xf
    s_nop 1
    v_mfma_f32_16x16x32_bf16 v[12:15], v[16:19], v[216:219], v[12:15]
    v_and_b32_dpp v20, v40, v8 row_newbcast:7 row_mask:0xf bank_mask:0xf
    v_and_b32_dpp v21, v40, v9 row_newbcast:7 row_mask:0xf bank_mask:0xf
    v_and_b32_dpp v22, v40, v10 row_newbcast:7 row_mask:0xf bank_mask:0xf
    v_and_b32_dpp v23, v40, v11 row_newbcast:7 row_mask:0xf bank_mask:0xf
    s_nop 1
    v_mfma_f32_16x16x32_bf16 v[12:15], v[20:23], v[220:223], v[12:15]
    v_and_b32_dpp v16, v40, v8 row_newbcast:8 row_mask:0xf bank_mask:0xf
    v_and_b32_dpp v17, v40, v9 row_newbcast:8 row_mask:0xf bank_mask:0xf
    v_and_b32_dpp v18, v40, v10 row_newbcast:8 row_mask:0xf bank_mask:0xf
    v_and_b32_dpp v19, v40, v11 row_newbcast:8 row_mask:0xf bank_mask:0xf
    s_nop 1
    v_mfma_f32_16x16x32_bf16 v[12:15], v[16:19], v[224:227], v[12:15]
    s_lshl_b32 s69, s4, 7
    v_lshl_add_u32 v46, v45, 4, s69
    s_cmp_eq_u32 s74, 1
    s_cselect_b32 s69, 896, 1073741824
    v_lshl_add_u32 v47, v45, 4, s69
    v_cmp_gt_u32 vcc, 8, v45
    s_nop 1
    v_cndmask_b32 v46, v47, v46, vcc
    s_mul_i32 s69, s30, 36864
    v_mul_u32_u24 v47, 1152, v44
    v_add3_u32 v46, v46, v47, s69
    s_mov_b32 s69, 0
    buffer_load_dwordx4 v[192:195], v46, s[56:59], s69 offen nt
    s_mov_b32 s69, 4608
    buffer_load_dwordx4 v[196:199], v46, s[56:59], s69 offen nt
    s_mov_b32 s69, 9216
    buffer_load_dwordx4 v[200:203], v46, s[56:59], s69 offen nt
    s_mov_b32 s69, 13824
    buffer_load_dwordx4 v[204:207], v46, s[56:59], s69 offen nt
    s_mov_b32 s69, 18432
    buffer_load_dwordx4 v[208:211], v46, s[56:59], s69 offen nt
    s_mov_b32 s69, 23040
    buffer_load_dwordx4 v[212:215], v46, s[56:59], s69 offen nt
    s_mov_b32 s69, 27648
    buffer_load_dwordx4 v[216:219], v46, s[56:59], s69 offen nt
    s_mov_b32 s69, 32256
    buffer_load_dwordx4 v[220:223], v46, s[56:59], s69 offen nt
    v_lshlrev_b32 v46, 5, v45
    v_lshl_add_u32 v46, v44, 4, v46
    s_lshl_b32 s69, s30, 9
    v_add_u32 v46, s69, v46
    s_mov_b32 exec_hi, 0
    ds_write_b128 v46, v[12:15] offset:24128
    s_mov_b32 exec_hi, -1
    s_waitcnt lgkmcnt(0)
    s_barrier
    s_cmp_lg_u32 s30, 0
    s_cbranch_scc1 L_yb_done
    v_and_b32 v46, 31, v1
    v_lshlrev_b32 v46, 4, v46
    ds_read_b128 v[16:19], v46 offset:24128
    ds_read_b128 v[20:23], v46 offset:24640
    ds_read_b128 v[24:27], v46 offset:25152
    ds_read_b128 v[28:31], v46 offset:25664
    s_waitcnt lgkmcnt(0)
    v_add_f32 v16, v16, v20
    v_add_f32 v24, v24, v28
    v_add_f32 v17, v17, v21
    v_add_f32 v25, v25, v29
    v_add_f32 v18, v18, v22
    v_add_f32 v26, v26, v30
    v_add_f32 v19, v19, v23
    v_add_f32 v27, v27, v31
    v_add_f32 v48, v16, v24
    v_mov_b32 v49, v59
    v_add_f32 v50, v17, v25
    v_mov_b32 v51, v59
    v_add_f32 v52, v18, v26
    v_mov_b32 v53, v59
    v_add_f32 v54, v19, v27
    v_mov_b32 v55, v59
L_yb_done:
    s_mov_b32 s68, 7
L_kpass:
    s_waitcnt vmcnt(4)
    buffer_load_dwordx4 v[88:91], v2, s[44:47], s66 offen offset:2048 nt
    buffer_load_dwordx4 v[92:95], v2, s[44:47], s66 offen offset:3072 nt
    s_add_u32 s66, s66, 16384
    s_and_b32 s66, s66, 0xfffff
    s_add_u32 s67, s67, 1
    v_dot2_f32_bf16 v24, v64, v4, 0
    v_dot2_f32_bf16 v25, v68, v4, 0
    v_dot2_f32_bf16 v24, v65, v5, v24
    v_dot2_f32_bf16 v25, v69, v5, v25
    v_dot2_f32_bf16 v24, v66, v6, v24
    v_dot2_f32_bf16 v25, v70, v6, v25
    v_dot2_f32_bf16 v24, v67, v7, v24
    v_dot2_f32_bf16 v25, v71, v7, v25
    s_nop 1
    v_add_f32_dpp v28, v24, v24 row_ror:8 row_mask:0xf bank_mask:0x3
    s_nop 1
    v_add_f32_dpp v28, v25, v25 row_ror:8 row_mask:0xf bank_mask:0xc
    s_waitcnt vmcnt(4)
    s_cmp_eq_u32 s67, 64
    s_cselect_b32 s44, s64, s44
    s_cselect_b32 s45, s65, s45
    s_cmp_ge_u32 s67, 128
    s_cselect_b32 s46, 0, s46
    buffer_load_dwordx4 v[96:99], v2, s[44:47], s66 offen offset:0 nt
    buffer_load_dwordx4 v[100:103], v2, s[44:47], s66 offen offset:1024 nt
    v_dot2_f32_bf16 v26, v72, v4, 0
    v_dot2_f32_bf16 v27, v76, v4, 0
    v_dot2_f32_bf16 v26, v73, v5, v26
    v_dot2_f32_bf16 v27, v77, v5, v27
    v_dot2_f32_bf16 v26, v74, v6, v26
    v_dot2_f32_bf16 v27, v78, v6, v27
    v_dot2_f32_bf16 v26, v75, v7, v26
    v_dot2_f32_bf16 v27, v79, v7, v27
    s_nop 1
    v_add_f32_dpp v29, v26, v26 row_ror:8 row_mask:0xf bank_mask:0x3
    s_nop 1
    v_add_f32_dpp v29, v27, v27 row_ror:8 row_mask:0xf bank_mask:0xc
    v_add_f32_dpp v30, v28, v28 row_half_mirror row_mask:0xf bank_mask:0x5
    s_nop 1
    v_add_f32_dpp v30, v29, v29 row_half_mirror row_mask:0xf bank_mask:0xa
    s_waitcnt vmcnt(4)
    buffer_load_dwordx4 v[104:107], v2, s[44:47], s66 offen offset:2048 nt
    buffer_load_dwordx4 v[108:111], v2, s[44:47], s66 offen offset:3072 nt
    s_add_u32 s66, s66, 16384
    s_and_b32 s66, s66, 0xfffff
    s_add_u32 s67, s67, 1
    v_dot2_f32_bf16 v24, v80, v4, 0
    v_dot2_f32_bf16 v25, v84, v4, 0
    v_dot2_f32_bf16 v24, v81, v5, v24
    v_dot2_f32_bf16 v25, v85, v5, v25
    v_dot2_f32_bf16 v24, v82, v6, v24
    v_dot2_f32_bf16 v25, v86, v6, v25
    v_dot2_f32_bf16 v24, v83, v7, v24
    v_dot2_f32_bf16 v25, v87, v7, v25
    s_nop 1
    v_add_f32_dpp v28, v24, v24 row_ror:8 row_mask:0xf bank_mask:0x3
    s_nop 1
    v_add_f32_dpp v28, v25, v25 row_ror:8 row_mask:0xf bank_mask:0xc
    s_waitcnt vmcnt(4)
    s_cmp_eq_u32 s67, 64
    s_cselect_b32 s44, s64, s44
    s_cselect_b32 s45, s65, s45
    s_cmp_ge_u32 s67, 128
    s_cselect_b32 s46, 0, s46
    buffer_load_dwordx4 v[112:115], v2, s[44:47], s66 offen offset:0 nt
    buffer_load_dwordx4 v[116:119], v2, s[44:47], s66 offen offset:1024 nt
    v_dot2_f32_bf16 v26, v88, v4, 0
    v_dot2_f32_bf16 v27, v92, v4, 0
    v_dot2_f32_bf16 v26, v89, v5, v26
    v_dot2_f32_bf16 v27, v93, v5, v27
    v_dot2_f32_bf16 v26, v90, v6, v26
    v_dot2_f32_bf16 v27, v94, v6, v27
    v_dot2_f32_bf16 v26, v91, v7, v26
    v_dot2_f32_bf16 v27, v95, v7, v27
    s_nop 1
    v_add_f32_dpp v29, v26, v26 row_ror:8 row_mask:0xf bank_mask:0x3
    s_nop 1
    v_add_f32_dpp v29, v27, v27 row_ror:8 row_mask:0xf bank_mask:0xc
    v_add_f32_dpp v31, v28, v28 row_half_mirror row_mask:0xf bank_mask:0x5
    s_nop 1
    v_add_f32_dpp v31, v29, v29 row_half_mirror row_mask:0xf bank_mask:0xa
    s_waitcnt vmcnt(4)
    buffer_load_dwordx4 v[120:123], v2, s[44:47], s66 offen offset:2048 nt
    buffer_load_dwordx4 v[124:127], v2, s[44:47], s66 offen offset:3072 nt
    s_add_u32 s66, s66, 16384
    s_and_b32 s66, s66, 0xfffff
    s_add_u32 s67, s67, 1
    v_dot2_f32_bf16 v24, v96, v4, 0
    v_dot2_f32_bf16 v25, v100, v4, 0
    v_dot2_f32_bf16 v24, v97, v5, v24
    v_dot2_f32_bf16 v25, v101, v5, v25
    v_dot2_f32_bf16 v24, v98, v6, v24
    v_dot2_f32_bf16 v25, v102, v6, v25
    v_dot2_f32_bf16 v24, v99, v7, v24
    v_dot2_f32_bf16 v25, v103, v7, v25
    s_nop 1
    v_add_f32_dpp v28, v24, v24 row_ror:8 row_mask:0xf bank_mask:0x3
    s_nop 1
    v_add_f32_dpp v28, v25, v25 row_ror:8 row_mask:0xf bank_mask:0xc
    s_waitcnt vmcnt(4)
    s_cmp_eq_u32 s67, 64
    s_cselect_b32 s44, s64, s44
    s_cselect_b32 s45, s65, s45
    s_cmp_ge_u32 s67, 128
    s_cselect_b32 s46, 0, s46
    buffer_load_dwordx4 v[128:131], v2, s[44:47], s66 offen offset:0 nt
    buffer_load_dwordx4 v[132:135], v2, s[44:47], s66 offen offset:1024 nt
    v_dot2_f32_bf16 v26, v104, v4, 0
    v_dot2_f32_bf16 v27, v108, v4, 0
    v_dot2_f32_bf16 v26, v105, v5, v26
    v_dot2_f32_bf16 v27, v109, v5, v27
    v_dot2_f32_bf16 v26, v106, v6, v26
    v_dot2_f32_bf16 v27, v110, v6, v27
    v_dot2_f32_bf16 v26, v107, v7, v26
    v_dot2_f32_bf16 v27, v111, v7, v27
    s_nop 1
    v_add_f32_dpp v29, v26, v26 row_ror:8 row_mask:0xf bank_mask:0x3
    s_nop 1
    v_add_f32_dpp v29, v27, v27 row_ror:8 row_mask:0xf bank_mask:0xc
    v_add_f32_dpp v32, v28, v28 row_half_mirror row_mask:0xf bank_mask:0x5
    s_nop 1
    v_add_f32_dpp v32, v29, v29 row_half_mirror row_mask:0xf bank_mask:0xa
    s_waitcnt vmcnt(4)
    buffer_load_dwordx4 v[136:139], v2, s[44:47], s66 offen offset:2048 nt
    buffer_load_dwordx4 v[140:143], v2, s[44:47], s66 offen offset:3072 nt
    s_add_u32 s66, s66, 16384
    s_and_b32 s66, s66, 0xfffff
    s_add_u32 s67, s67, 1
    v_dot2_f32_bf16 v24, v112, v4, 0
    v_dot2_f32_bf16 v25, v116, v4, 0
    v_dot2_f32_bf16 v24, v113, v5, v24
    v_dot2_f32_bf16 v25, v117, v5, v25
    v_dot2_f32_bf16 v24, v114, v6, v24
    v_dot2_f32_bf16 v25, v118, v6, v25
    v_dot2_f32_bf16 v24, v115, v7, v24
    v_dot2_f32_bf16 v25, v119, v7, v25
    s_nop 1
    v_add_f32_dpp v28, v24, v24 row_ror:8 row_mask:0xf bank_mask:0x3
    s_nop 1
    v_add_f32_dpp v28, v25, v25 row_ror:8 row_mask:0xf bank_mask:0xc
    s_waitcnt vmcnt(4)
    s_cmp_eq_u32 s67, 64
    s_cselect_b32 s44, s64, s44
    s_cselect_b32 s45, s65, s45
    s_cmp_ge_u32 s67, 128
    s_cselect_b32 s46, 0, s46
    buffer_load_dwordx4 v[144:147], v2, s[44:47], s66 offen offset:0 nt
    buffer_load_dwordx4 v[148:151], v2, s[44:47], s66 offen offset:1024 nt
    v_dot2_f32_bf16 v26, v120, v4, 0
    v_dot2_f32_bf16 v27, v124, v4, 0
    v_dot2_f32_bf16 v26, v121, v5, v26
    v_dot2_f32_bf16 v27, v125, v5, v27
    v_dot2_f32_bf16 v26, v122, v6, v26
    v_dot2_f32_bf16 v27, v126, v6, v27
    v_dot2_f32_bf16 v26, v123, v7, v26
    v_dot2_f32_bf16 v27, v127, v7, v27
    s_nop 1
    v_add_f32_dpp v29, v26, v26 row_ror:8 row_mask:0xf bank_mask:0x3
    s_nop 1
    v_add_f32_dpp v29, v27, v27 row_ror:8 row_mask:0xf bank_mask:0xc
    v_add_f32_dpp v33, v28, v28 row_half_mirror row_mask:0xf bank_mask:0x5
    s_nop 1
    v_add_f32_dpp v33, v29, v29 row_half_mirror row_mask:0xf bank_mask:0xa
    v_add_f32_dpp v24, v30, v30 quad_perm:[2,3,0,1] row_mask:0xf bank_mask:0xf
    v_add_f32_dpp v25, v31, v31 quad_perm:[2,3,0,1] row_mask:0xf bank_mask:0xf
    v_add_f32_dpp v26, v32, v32 quad_perm:[2,3,0,1] row_mask:0xf bank_mask:0xf
    v_add_f32_dpp v27, v33, v33 quad_perm:[2,3,0,1] row_mask:0xf bank_mask:0xf
    v_cndmask_b32 v34, v24, v25, s[80:81]
    v_cndmask_b32 v46, v26, v27, s[80:81]
    s_nop 0
    v_add_f32_dpp v28, v34, v34 quad_perm:[1,0,3,2] row_mask:0xf bank_mask:0xf
    v_add_f32_dpp v29, v46, v46 quad_perm:[1,0,3,2] row_mask:0xf bank_mask:0xf
    v_cndmask_b32 v36, v28, v29, s[82:83]
    v_cvt_pk_bf16_f32 v36, 0, v36
    v_mul_f32 v36, s86, v36
    v_cvt_pk_bf16_f32 v36, 0, v36
    v_max_f32 v37, v37, v36
    ds_write_b32 v42, v36 offset:0
    v_add_u32 v42, 256, v42
    s_waitcnt vmcnt(4)
    buffer_load_dwordx4 v[152:155], v2, s[44:47], s66 offen offset:2048 nt
    buffer_load_dwordx4 v[156:159], v2, s[44:47], s66 offen offset:3072 nt
    s_add_u32 s66, s66, 16384
    s_and_b32 s66, s66, 0xfffff
    s_add_u32 s67, s67, 1
    v_dot2_f32_bf16 v24, v128, v4, 0
    v_dot2_f32_bf16 v25, v132, v4, 0
    v_dot2_f32_bf16 v24, v129, v5, v24
    v_dot2_f32_bf16 v25, v133, v5, v25
    v_dot2_f32_bf16 v24, v130, v6, v24
    v_dot2_f32_bf16 v25, v134, v6, v25
    v_dot2_f32_bf16 v24, v131, v7, v24
    v_dot2_f32_bf16 v25, v135, v7, v25
    s_nop 1
    v_add_f32_dpp v28, v24, v24 row_ror:8 row_mask:0xf bank_mask:0x3
    s_nop 1
    v_add_f32_dpp v28, v25, v25 row_ror:8 row_mask:0xf bank_mask:0xc
    s_waitcnt vmcnt(4)
    s_cmp_eq_u32 s67, 64
    s_cselect_b32 s44, s64, s44
    s_cselect_b32 s45, s65, s45
    s_cmp_ge_u32 s67, 128
    s_cselect_b32 s46, 0, s46
    buffer_load_dwordx4 v[160:163], v2, s[44:47], s66 offen offset:0 nt
    buffer_load_dwordx4 v[164:167], v2, s[44:47], s66 offen offset:1024 nt
    v_dot2_f32_bf16 v26, v136, v4, 0
    v_dot2_f32_bf16 v27, v140, v4, 0
    v_dot2_f32_bf16 v26, v137, v5, v26
    v_dot2_f32_bf16 v27, v141, v5, v27
    v_dot2_f32_bf16 v26, v138, v6, v26
    v_dot2_f32_bf16 v27, v142, v6, v27
    v_dot2_f32_bf16 v26, v139, v7, v26
    v_dot2_f32_bf16 v27, v143, v7, v27
    s_nop 1
    v_add_f32_dpp v29, v26, v26 row_ror:8 row_mask:0xf bank_mask:0x3
    s_nop 1
    v_add_f32_dpp v29, v27, v27 row_ror:8 row_mask:0xf bank_mask:0xc
    v_add_f32_dpp v30, v28, v28 row_half_mirror row_mask:0xf bank_mask:0x5
    s_nop 1
    v_add_f32_dpp v30, v29, v29 row_half_mirror row_mask:0xf bank_mask:0xa
    s_waitcnt vmcnt(4)
    buffer_load_dwordx4 v[168:171], v2, s[44:47], s66 offen offset:2048 nt
    buffer_load_dwordx4 v[172:175], v2, s[44:47], s66 offen offset:3072 nt
    s_add_u32 s66, s66, 16384
    s_and_b32 s66, s66, 0xfffff
    s_add_u32 s67, s67, 1
    v_dot2_f32_bf16 v24, v144, v4, 0
    v_dot2_f32_bf16 v25, v148, v4, 0
    v_dot2_f32_bf16 v24, v145, v5, v24
    v_dot2_f32_bf16 v25, v149, v5, v25
    v_dot2_f32_bf16 v24, v146, v6, v24
    v_dot2_f32_bf16 v25, v150, v6, v25
    v_dot2_f32_bf16 v24, v147, v7, v24
    v_dot2_f32_bf16 v25, v151, v7, v25
    s_nop 1
    v_add_f32_dpp v28, v24, v24 row_ror:8 row_mask:0xf bank_mask:0x3
    s_nop 1
    v_add_f32_dpp v28, v25, v25 row_ror:8 row_mask:0xf bank_mask:0xc
    s_waitcnt vmcnt(4)
    s_cmp_eq_u32 s67, 64
    s_cselect_b32 s44, s64, s44
    s_cselect_b32 s45, s65, s45
    s_cmp_ge_u32 s67, 128
    s_cselect_b32 s46, 0, s46
    buffer_load_dwordx4 v[176:179], v2, s[44:47], s66 offen offset:0 nt
    buffer_load_dwordx4 v[180:183], v2, s[44:47], s66 offen offset:1024 nt
    v_dot2_f32_bf16 v26, v152, v4, 0
    v_dot2_f32_bf16 v27, v156, v4, 0
    v_dot2_f32_bf16 v26, v153, v5, v26
    v_dot2_f32_bf16 v27, v157, v5, v27
    v_dot2_f32_bf16 v26, v154, v6, v26
    v_dot2_f32_bf16 v27, v158, v6, v27
    v_dot2_f32_bf16 v26, v155, v7, v26
    v_dot2_f32_bf16 v27, v159, v7, v27
    s_nop 1
    v_add_f32_dpp v29, v26, v26 row_ror:8 row_mask:0xf bank_mask:0x3
    s_nop 1
    v_add_f32_dpp v29, v27, v27 row_ror:8 row_mask:0xf bank_mask:0xc
    v_add_f32_dpp v31, v28, v28 row_half_mirror row_mask:0xf bank_mask:0x5
    s_nop 1
    v_add_f32_dpp v31, v29, v29 row_half_mirror row_mask:0xf bank_mask:0xa
    s_waitcnt vmcnt(4)
    buffer_load_dwordx4 v[184:187], v2, s[44:47], s66 offen offset:2048 nt
    buffer_load_dwordx4 v[188:191], v2, s[44:47], s66 offen offset:3072 nt
    s_add_u32 s66, s66, 16384
    s_and_b32 s66, s66, 0xfffff
    s_add_u32 s67, s67, 1
    v_dot2_f32_bf16 v24, v160, v4, 0
    v_dot2_f32_bf16 v25, v164, v4, 0
    v_dot2_f32_bf16 v24, v161, v5, v24
    v_dot2_f32_bf16 v25, v165, v5, v25
    v_dot2_f32_bf16 v24, v162, v6, v24
    v_dot2_f32_bf16 v25, v166, v6, v25
    v_dot2_f32_bf16 v24, v163, v7, v24
    v_dot2_f32_bf16 v25, v167, v7, v25
    s_nop 1
    v_add_f32_dpp v28, v24, v24 row_ror:8 row_mask:0xf bank_mask:0x3
    s_nop 1
    v_add_f32_dpp v28, v25, v25 row_ror:8 row_mask:0xf bank_mask:0xc
    s_waitcnt vmcnt(4)
    s_cmp_eq_u32 s67, 64
    s_cselect_b32 s44, s64, s44
    s_cselect_b32 s45, s65, s45
    s_cmp_ge_u32 s67, 128
    s_cselect_b32 s46, 0, s46
    buffer_load_dwordx4 v[64:67], v2, s[44:47], s66 offen offset:0 nt
    buffer_load_dwordx4 v[68:71], v2, s[44:47], s66 offen offset:1024 nt
    v_dot2_f32_bf16 v26, v168, v4, 0
    v_dot2_f32_bf16 v27, v172, v4, 0
    v_dot2_f32_bf16 v26, v169, v5, v26
    v_dot2_f32_bf16 v27, v173, v5, v27
    v_dot2_f32_bf16 v26, v170, v6, v26
    v_dot2_f32_bf16 v27, v174, v6, v27
    v_dot2_f32_bf16 v26, v171, v7, v26
    v_dot2_f32_bf16 v27, v175, v7, v27
    s_nop 1
    v_add_f32_dpp v29, v26, v26 row_ror:8 row_mask:0xf bank_mask:0x3
    s_nop 1
    v_add_f32_dpp v29, v27, v27 row_ror:8 row_mask:0xf bank_mask:0xc
    v_add_f32_dpp v32, v28, v28 row_half_mirror row_mask:0xf bank_mask:0x5
    s_nop 1
    v_add_f32_dpp v32, v29, v29 row_half_mirror row_mask:0xf bank_mask:0xa
    s_waitcnt vmcnt(4)
    buffer_load_dwordx4 v[72:75], v2, s[44:47], s66 offen offset:2048 nt
    buffer_load_dwordx4 v[76:79], v2, s[44:47], s66 offen offset:3072 nt
    s_add_u32 s66, s66, 16384
    s_and_b32 s66, s66, 0xfffff
    s_add_u32 s67, s67, 1
    v_dot2_f32_bf16 v24, v176, v4, 0
    v_dot2_f32_bf16 v25, v180, v4, 0
    v_dot2_f32_bf16 v24, v177, v5, v24
    v_dot2_f32_bf16 v25, v181, v5, v25
    v_dot2_f32_bf16 v24, v178, v6, v24
    v_dot2_f32_bf16 v25, v182, v6, v25
    v_dot2_f32_bf16 v24, v179, v7, v24
    v_dot2_f32_bf16 v25, v183, v7, v25
    s_nop 1
    v_add_f32_dpp v28, v24, v24 row_ror:8 row_mask:0xf bank_mask:0x3
    s_nop 1
    v_add_f32_dpp v28, v25, v25 row_ror:8 row_mask:0xf bank_mask:0xc
    s_waitcnt vmcnt(4)
    s_cmp_eq_u32 s67, 64
    s_cselect_b32 s44, s64, s44
    s_cselect_b32 s45, s65, s45
    s_cmp_ge_u32 s67, 128
    s_cselect_b32 s46, 0, s46
    buffer_load_dwordx4 v[80:83], v2, s[44:47], s66 offen offset:0 nt
    buffer_load_dwordx4 v[84:87], v2, s[44:47], s66 offen offset:1024 nt
    v_dot2_f32_bf16 v26, v184, v4, 0
    v_dot2_f32_bf16 v27, v188, v4, 0
    v_dot2_f32_bf16 v26, v185, v5, v26
    v_dot2_f32_bf16 v27, v189, v5, v27
    v_dot2_f32_bf16 v26, v186, v6, v26
    v_dot2_f32_bf16 v27, v190, v6, v27
    v_dot2_f32_bf16 v26, v187, v7, v26
    v_dot2_f32_bf16 v27, v191, v7, v27
    s_nop 1
    v_add_f32_dpp v29, v26, v26 row_ror:8 row_mask:0xf bank_mask:0x3
    s_nop 1
    v_add_f32_dpp v29, v27, v27 row_ror:8 row_mask:0xf bank_mask:0xc
    v_add_f32_dpp v33, v28, v28 row_half_mirror row_mask:0xf bank_mask:0x5
    s_nop 1
    v_add_f32_dpp v33, v29, v29 row_half_mirror row_mask:0xf bank_mask:0xa
    v_add_f32_dpp v24, v30, v30 quad_perm:[2,3,0,1] row_mask:0xf bank_mask:0xf
    v_add_f32_dpp v25, v31, v31 quad_perm:[2,3,0,1] row_mask:0xf bank_mask:0xf
    v_add_f32_dpp v26, v32, v32 quad_perm:[2,3,0,1] row_mask:0xf bank_mask:0xf
    v_add_f32_dpp v27, v33, v33 quad_perm:[2,3,0,1] row_mask:0xf bank_mask:0xf
    v_cndmask_b32 v34, v24, v25, s[80:81]
    v_cndmask_b32 v46, v26, v27, s[80:81]
    s_nop 0
    v_add_f32_dpp v28, v34, v34 quad_perm:[1,0,3,2] row_mask:0xf bank_mask:0xf
    v_add_f32_dpp v29, v46, v46 quad_perm:[1,0,3,2] row_mask:0xf bank_mask:0xf
    v_cndmask_b32 v36, v28, v29, s[82:83]
    v_cvt_pk_bf16_f32 v36, 0, v36
    v_mul_f32 v36, s86, v36
    v_cvt_pk_bf16_f32 v36, 0, v36
    v_max_f32 v37, v37, v36
    ds_write_b32 v42, v36 offset:0
    v_add_u32 v42, 256, v42
    s_sub_u32 s68, s68, 1
    s_cmp_lg_u32 s68, 0
    s_cbranch_scc1 L_kpass
    v_subrev_u32 v42, 4096, v42
    s_waitcnt lgkmcnt(0)
    ds_read_b32 v41, v42 offset:0
    v_max_f32_dpp v37, v37, v37 row_ror:8 row_mask:0xf bank_mask:0xf
    s_nop 1
    v_max_f32_dpp v37, v37, v37 row_ror:4 row_mask:0xf bank_mask:0xf
    s_nop 1
    v_max_f32_dpp v37, v37, v37 row_ror:2 row_mask:0xf bank_mask:0xf
    s_nop 1
    v_max_f32_dpp v37, v37, v37 row_ror:1 row_mask:0xf bank_mask:0xf
    v_mov_b32 v46, v37
    s_nop 1
    v_permlane16_swap_b32 v37, v46
    v_max_f32 v37, v37, v46
    v_mov_b32 v46, v37
    s_nop 1
    v_permlane32_swap_b32 v37, v46
    v_max_f32 v37, v37, v46
    v_mul_f32 v39, s87, v37
    v_sub_f32 v39, 0, v39
    v_mov_b32 v38, 0
    v_mov_b32 v12, 0
    v_mov_b32 v13, 0
    v_mov_b32 v14, 0
    v_mov_b32 v15, 0
    s_mov_b32 s68, 4
L_vpass:
    s_waitcnt lgkmcnt(0)
    v_fma_f32 v46, v41, s87, v39
    v_add_u32 v42, 256, v42
    v_exp_f32 v46, v46
    ds_read_b32 v41, v42 offset:0
    v_cvt_pk_bf16_f32 v40, v46, v46
    v_add_f32 v38, v38, v46
    s_nop 0
    v_and_b32_dpp v16, v40, v8 row_newbcast:0 row_mask:0xf bank_mask:0xf
    v_and_b32_dpp v17, v40, v9 row_newbcast:0 row_mask:0xf bank_mask:0xf
    v_and_b32_dpp v18, v40, v10 row_newbcast:0 row_mask:0xf bank_mask:0xf
    v_and_b32_dpp v19, v40, v11 row_newbcast:0 row_mask:0xf bank_mask:0xf
    s_waitcnt vmcnt(4)
    buffer_load_dwordx4 v[88:91], v2, s[44:47], s66 offen offset:2048 nt
    buffer_load_dwordx4 v[92:95], v2, s[44:47], s66 offen offset:3072 nt
    s_add_u32 s66, s66, 16384
    s_and_b32 s66, s66, 0xfffff
    s_add_u32 s67, s67, 1
    v_and_b32_dpp v20, v40, v8 row_newbcast:8 row_mask:0xf bank_mask:0xf
    v_and_b32_dpp v21, v40, v9 row_newbcast:8 row_mask:0xf bank_mask:0xf
    v_and_b32_dpp v22, v40, v10 row_newbcast:8 row_mask:0xf bank_mask:0xf
    v_and_b32_dpp v23, v40, v11 row_newbcast:8 row_mask:0xf bank_mask:0xf
    v_mfma_f32_16x16x32_bf16 v[12:15], v[16:19], v[64:67], v[12:15]
    v_and_b32_dpp v16, v40, v8 row_newbcast:4 row_mask:0xf bank_mask:0xf
    v_and_b32_dpp v17, v40, v9 row_newbcast:4 row_mask:0xf bank_mask:0xf
    v_and_b32_dpp v18, v40, v10 row_newbcast:4 row_mask:0xf bank_mask:0xf
    v_and_b32_dpp v19, v40, v11 row_newbcast:4 row_mask:0xf bank_mask:0xf
    v_mfma_f32_16x16x32_bf16 v[12:15], v[20:23], v[68:71], v[12:15]
    s_waitcnt vmcnt(4)
    s_cmp_eq_u32 s67, 64
    s_cselect_b32 s44, s64, s44
    s_cselect_b32 s45, s65, s45
    s_cmp_ge_u32 s67, 128
    s_cselect_b32 s46, 0, s46
    buffer_load_dwordx4 v[96:99], v2, s[44:47], s66 offen offset:0 nt
    buffer_load_dwordx4 v[100:103], v2, s[44:47], s66 offen offset:1024 nt
    v_and_b32_dpp v20, v40, v8 row_newbcast:12 row_mask:0xf bank_mask:0xf
    v_and_b32_dpp v21, v40, v9 row_newbcast:12 row_mask:0xf bank_mask:0xf
    v_and_b32_dpp v22, v40, v10 row_newbcast:12 row_mask:0xf bank_mask:0xf
    v_and_b32_dpp v23, v40, v11 row_newbcast:12 row_mask:0xf bank_mask:0xf
    v_mfma_f32_16x16x32_bf16 v[12:15], v[16:19], v[72:75], v[12:15]
    v_and_b32_dpp v16, v40, v8 row_newbcast:2 row_mask:0xf bank_mask:0xf
    v_and_b32_dpp v17, v40, v9 row_newbcast:2 row_mask:0xf bank_mask:0xf
    v_and_b32_dpp v18, v40, v10 row_newbcast:2 row_mask:0xf bank_mask:0xf
    v_and_b32_dpp v19, v40, v11 row_newbcast:2 row_mask:0xf bank_mask:0xf
    v_mfma_f32_16x16x32_bf16 v[12:15], v[20:23], v[76:79], v[12:15]
    s_waitcnt vmcnt(4)
    buffer_load_dwordx4 v[104:107], v2, s[44:47], s66 offen offset:2048 nt
    buffer_load_dwordx4 v[108:111], v2, s[44:47], s66 offen offset:3072 nt
    s_add_u32 s66, s66, 16384
    s_and_b32 s66, s66, 0xfffff
    s_add_u32 s67, s67, 1
    v_and_b32_dpp v20, v40, v8 row_newbcast:10 row_mask:0xf bank_mask:0xf
    v_and_b32_dpp v21, v40, v9 row_newbcast:10 row_mask:0xf bank_mask:0xf
    v_and_b32_dpp v22, v40, v10 row_newbcast:10 row_mask:0xf bank_mask:0xf
    v_and_b32_dpp v23, v40, v11 row_newbcast:10 row_mask:0xf bank_mask:0xf
    v_mfma_f32_16x16x32_bf16 v[12:15], v[16:19], v[80:83], v[12:15]
    v_and_b32_dpp v16, v40, v8 row_newbcast:6 row_mask:0xf bank_mask:0xf
    v_and_b32_dpp v17, v40, v9 row_newbcast:6 row_mask:0xf bank_mask:0xf
    v_and_b32_dpp v18, v40, v10 row_newbcast:6 row_mask:0xf bank_mask:0xf
    v_and_b32_dpp v19, v40, v11 row_newbcast:6 row_mask:0xf bank_mask:0xf
    v_mfma_f32_16x16x32_bf16 v[12:15], v[20:23], v[84:87], v[12:15]
    s_waitcnt vmcnt(4)
    s_cmp_eq_u32 s67, 64
    s_cselect_b32 s44, s64, s44
    s_cselect_b32 s45, s65, s45
    s_cmp_ge_u32 s67, 128
    s_cselect_b32 s46, 0, s46
    buffer_load_dwordx4 v[112:115], v2, s[44:47], s66 offen offset:0 nt
    buffer_load_dwordx4 v[116:119], v2, s[44:47], s66 offen offset:1024 nt
    v_and_b32_dpp v20, v40, v8 row_newbcast:14 row_mask:0xf bank_mask:0xf
    v_and_b32_dpp v21, v40, v9 row_newbcast:14 row_mask:0xf bank_mask:0xf
    v_and_b32_dpp v22, v40, v10 row_newbcast:14 row_mask:0xf bank_mask:0xf
    v_and_b32_dpp v23, v40, v11 row_newbcast:14 row_mask:0xf bank_mask:0xf
    v_mfma_f32_16x16x32_bf16 v[12:15], v[16:19], v[88:91], v[12:15]
    v_and_b32_dpp v16, v40, v8 row_newbcast:1 row_mask:0xf bank_mask:0xf
    v_and_b32_dpp v17, v40, v9 row_newbcast:1 row_mask:0xf bank_mask:0xf
    v_and_b32_dpp v18, v40, v10 row_newbcast:1 row_mask:0xf bank_mask:0xf
    v_and_b32_dpp v19, v40, v11 row_newbcast:1 row_mask:0xf bank_mask:0xf
    v_mfma_f32_16x16x32_bf16 v[12:15], v[20:23], v[92:95], v[12:15]
    s_waitcnt vmcnt(4)
    buffer_load_dwordx4 v[120:123], v2, s[44:47], s66 offen offset:2048 nt
    buffer_load_dwordx4 v[124:127], v2, s[44:47], s66 offen offset:3072 nt
    s_add_u32 s66, s66, 16384
    s_and_b32 s66, s66, 0xfffff
    s_add_u32 s67, s67, 1
    v_and_b32_dpp v20, v40, v8 row_newbcast:9 row_mask:0xf bank_mask:0xf
    v_and_b32_dpp v21, v40, v9 row_newbcast:9 row_mask:0xf bank_mask:0xf
    v_and_b32_dpp v22, v40, v10 row_newbcast:9 row_mask:0xf bank_mask:0xf
    v_and_b32_dpp v23, v40, v11 row_newbcast:9 row_mask:0xf bank_mask:0xf
    v_mfma_f32_16x16x32_bf16 v[12:15], v[16:19], v[96:99], v[12:15]
    v_and_b32_dpp v16, v40, v8 row_newbcast:5 row_mask:0xf bank_mask:0xf
    v_and_b32_dpp v17, v40, v9 row_newbcast:5 row_mask:0xf bank_mask:0xf
    v_and_b32_dpp v18, v40, v10 row_newbcast:5 row_mask:0xf bank_mask:0xf
    v_and_b32_dpp v19, v40, v11 row_newbcast:5 row_mask:0xf bank_mask:0xf
    v_mfma_f32_16x16x32_bf16 v[12:15], v[20:23], v[100:103], v[12:15]
    s_waitcnt vmcnt(4)
    s_cmp_eq_u32 s67, 64
    s_cselect_b32 s44, s64, s44
    s_cselect_b32 s45, s65, s45
    s_cmp_ge_u32 s67, 128
    s_cselect_b32 s46, 0, s46
    buffer_load_dwordx4 v[128:131], v2, s[44:47], s66 offen offset:0 nt
    buffer_load_dwordx4 v[132:135], v2, s[44:47], s66 offen offset:1024 nt
    v_and_b32_dpp v20, v40, v8 row_newbcast:13 row_mask:0xf bank_mask:0xf
    v_and_b32_dpp v21, v40, v9 row_newbcast:13 row_mask:0xf bank_mask:0xf
    v_and_b32_dpp v22, v40, v10 row_newbcast:13 row_mask:0xf bank_mask:0xf
    v_and_b32_dpp v23, v40, v11 row_newbcast:13 row_mask:0xf bank_mask:0xf
    v_mfma_f32_16x16x32_bf16 v[12:15], v[16:19], v[104:107], v[12:15]
    v_and_b32_dpp v16, v40, v8 row_newbcast:3 row_mask:0xf bank_mask:0xf
    v_and_b32_dpp v17, v40, v9 row_newbcast:3 row_mask:0xf bank_mask:0xf
    v_and_b32_dpp v18, v40, v10 row_newbcast:3 row_mask:0xf bank_mask:0xf
    v_and_b32_dpp v19, v40, v11 row_newbcast:3 row_mask:0xf bank_mask:0xf
    v_mfma_f32_16x16x32_bf16 v[12:15], v[20:23], v[108:111], v[12:15]
    s_waitcnt vmcnt(4)
    buffer_load_dwordx4 v[136:139], v2, s[44:47], s66 offen offset:2048 nt
    buffer_load_dwordx4 v[140:143], v2, s[44:47], s66 offen offset:3072 nt
    s_add_u32 s66, s66, 16384
    s_and_b32 s66, s66, 0xfffff
    s_add_u32 s67, s67, 1
    v_and_b32_dpp v20, v40, v8 row_newbcast:11 row_mask:0xf bank_mask:0xf
    v_and_b32_dpp v21, v40, v9 row_newbcast:11 row_mask:0xf bank_mask:0xf
    v_and_b32_dpp v22, v40, v10 row_newbcast:11 row_mask:0xf bank_mask:0xf
    v_and_b32_dpp v23, v40, v11 row_newbcast:11 row_mask:0xf bank_mask:0xf
    v_mfma_f32_16x16x32_bf16 v[12:15], v[16:19], v[112:115], v[12:15]
    v_and_b32_dpp v16, v40, v8 row_newbcast:7 row_mask:0xf bank_mask:0xf
    v_and_b32_dpp v17, v40, v9 row_newbcast:7 row_mask:0xf bank_mask:0xf
    v_and_b32_dpp v18, v40, v10 row_newbcast:7 row_mask:0xf bank_mask:0xf
    v_and_b32_dpp v19, v40, v11 row_newbcast:7 row_mask:0xf bank_mask:0xf
    v_mfma_f32_16x16x32_bf16 v[12:15], v[20:23], v[116:119], v[12:15]
    s_waitcnt vmcnt(4)
    s_cmp_eq_u32 s67, 64
    s_cselect_b32 s44, s64, s44
    s_cselect_b32 s45, s65, s45
    s_cmp_ge_u32 s67, 128
    s_cselect_b32 s46, 0, s46
    buffer_load_dwordx4 v[144:147], v2, s[44:47], s66 offen offset:0 nt
    buffer_load_dwordx4 v[148:151], v2, s[44:47], s66 offen offset:1024 nt
    v_and_b32_dpp v20, v40, v8 row_newbcast:15 row_mask:0xf bank_mask:0xf
    v_and_b32_dpp v21, v40, v9 row_newbcast:15 row_mask:0xf bank_mask:0xf
    v_and_b32_dpp v22, v40, v10 row_newbcast:15 row_mask:0xf bank_mask:0xf
    v_and_b32_dpp v23, v40, v11 row_newbcast:15 row_mask:0xf bank_mask:0xf
    v_mfma_f32_16x16x32_bf16 v[12:15], v[16:19], v[120:123], v[12:15]
    s_nop 1
    v_mfma_f32_16x16x32_bf16 v[12:15], v[20:23], v[124:127], v[12:15]
    s_waitcnt lgkmcnt(0)
    v_fma_f32 v46, v41, s87, v39
    v_add_u32 v42, 256, v42
    v_exp_f32 v46, v46
    ds_read_b32 v41, v42 offset:0
    v_cvt_pk_bf16_f32 v40, v46, v46
    v_add_f32 v38, v38, v46
    s_nop 0
    v_and_b32_dpp v16, v40, v8 row_newbcast:0 row_mask:0xf bank_mask:0xf
    v_and_b32_dpp v17, v40, v9 row_newbcast:0 row_mask:0xf bank_mask:0xf
    v_and_b32_dpp v18, v40, v10 row_newbcast:0 row_mask:0xf bank_mask:0xf
    v_and_b32_dpp v19, v40, v11 row_newbcast:0 row_mask:0xf bank_mask:0xf
    s_waitcnt vmcnt(4)
    buffer_load_dwordx4 v[152:155], v2, s[44:47], s66 offen offset:2048 nt
    buffer_load_dwordx4 v[156:159], v2, s[44:47], s66 offen offset:3072 nt
    s_add_u32 s66, s66, 16384
    s_and_b32 s66, s66, 0xfffff
    s_add_u32 s67, s67, 1
    v_and_b32_dpp v20, v40, v8 row_newbcast:8 row_mask:0xf bank_mask:0xf
    v_and_b32_dpp v21, v40, v9 row_newbcast:8 row_mask:0xf bank_mask:0xf
    v_and_b32_dpp v22, v40, v10 row_newbcast:8 row_mask:0xf bank_mask:0xf
    v_and_b32_dpp v23, v40, v11 row_newbcast:8 row_mask:0xf bank_mask:0xf
    v_mfma_f32_16x16x32_bf16 v[12:15], v[16:19], v[128:131], v[12:15]
    v_and_b32_dpp v16, v40, v8 row_newbcast:4 row_mask:0xf bank_mask:0xf
    v_and_b32_dpp v17, v40, v9 row_newbcast:4 row_mask:0xf bank_mask:0xf
    v_and_b32_dpp v18, v40, v10 row_newbcast:4 row_mask:0xf bank_mask:0xf
    v_and_b32_dpp v19, v40, v11 row_newbcast:4 row_mask:0xf bank_mask:0xf
    v_mfma_f32_16x16x32_bf16 v[12:15], v[20:23], v[132:135], v[12:15]
    s_waitcnt vmcnt(4)
    s_cmp_eq_u32 s67, 64
    s_cselect_b32 s44, s64, s44
    s_cselect_b32 s45, s65, s45
    s_cmp_ge_u32 s67, 128
    s_cselect_b32 s46, 0, s46
    buffer_load_dwordx4 v[160:163], v2, s[44:47], s66 offen offset:0 nt
    buffer_load_dwordx4 v[164:167], v2, s[44:47], s66 offen offset:1024 nt
    v_and_b32_dpp v20, v40, v8 row_newbcast:12 row_mask:0xf bank_mask:0xf
    v_and_b32_dpp v21, v40, v9 row_newbcast:12 row_mask:0xf bank_mask:0xf
    v_and_b32_dpp v22, v40, v10 row_newbcast:12 row_mask:0xf bank_mask:0xf
    v_and_b32_dpp v23, v40, v11 row_newbcast:12 row_mask:0xf bank_mask:0xf
    v_mfma_f32_16x16x32_bf16 v[12:15], v[16:19], v[136:139], v[12:15]
    v_and_b32_dpp v16, v40, v8 row_newbcast:2 row_mask:0xf bank_mask:0xf
    v_and_b32_dpp v17, v40, v9 row_newbcast:2 row_mask:0xf bank_mask:0xf
    v_and_b32_dpp v18, v40, v10 row_newbcast:2 row_mask:0xf bank_mask:0xf
    v_and_b32_dpp v19, v40, v11 row_newbcast:2 row_mask:0xf bank_mask:0xf
    v_mfma_f32_16x16x32_bf16 v[12:15], v[20:23], v[140:143], v[12:15]
    s_waitcnt vmcnt(4)
    buffer_load_dwordx4 v[168:171], v2, s[44:47], s66 offen offset:2048 nt
    buffer_load_dwordx4 v[172:175], v2, s[44:47], s66 offen offset:3072 nt
    s_add_u32 s66, s66, 16384
    s_and_b32 s66, s66, 0xfffff
    s_add_u32 s67, s67, 1
    v_and_b32_dpp v20, v40, v8 row_newbcast:10 row_mask:0xf bank_mask:0xf
    v_and_b32_dpp v21, v40, v9 row_newbcast:10 row_mask:0xf bank_mask:0xf
    v_and_b32_dpp v22, v40, v10 row_newbcast:10 row_mask:0xf bank_mask:0xf
    v_and_b32_dpp v23, v40, v11 row_newbcast:10 row_mask:0xf bank_mask:0xf
    v_mfma_f32_16x16x32_bf16 v[12:15], v[16:19], v[144:147], v[12:15]
    v_and_b32_dpp v16, v40, v8 row_newbcast:6 row_mask:0xf bank_mask:0xf
    v_and_b32_dpp v17, v40, v9 row_newbcast:6 row_mask:0xf bank_mask:0xf
    v_and_b32_dpp v18, v40, v10 row_newbcast:6 row_mask:0xf bank_mask:0xf
    v_and_b32_dpp v19, v40, v11 row_newbcast:6 row_mask:0xf bank_mask:0xf
    v_mfma_f32_16x16x32_bf16 v[12:15], v[20:23], v[148:151], v[12:15]
    s_waitcnt vmcnt(4)
    s_cmp_eq_u32 s67, 64
    s_cselect_b32 s44, s64, s44
    s_cselect_b32 s45, s65, s45
    s_cmp_ge_u32 s67, 128
    s_cselect_b32 s46, 0, s46
    buffer_load_dwordx4 v[176:179], v2, s[44:47], s66 offen offset:0 nt
    buffer_load_dwordx4 v[180:183], v2, s[44:47], s66 offen offset:1024 nt
    v_and_b32_dpp v20, v40, v8 row_newbcast:14 row_mask:0xf bank_mask:0xf
    v_and_b32_dpp v21, v40, v9 row_newbcast:14 row_mask:0xf bank_mask:0xf
    v_and_b32_dpp v22, v40, v10 row_newbcast:14 row_mask:0xf bank_mask:0xf
    v_and_b32_dpp v23, v40, v11 row_newbcast:14 row_mask:0xf bank_mask:0xf
    v_mfma_f32_16x16x32_bf16 v[12:15], v[16:19], v[152:155], v[12:15]
    v_and_b32_dpp v16, v40, v8 row_newbcast:1 row_mask:0xf bank_mask:0xf
    v_and_b32_dpp v17, v40, v9 row_newbcast:1 row_mask:0xf bank_mask:0xf
    v_and_b32_dpp v18, v40, v10 row_newbcast:1 row_mask:0xf bank_mask:0xf
    v_and_b32_dpp v19, v40, v11 row_newbcast:1 row_mask:0xf bank_mask:0xf
    v_mfma_f32_16x16x32_bf16 v[12:15], v[20:23], v[156:159], v[12:15]
    s_waitcnt vmcnt(4)
    buffer_load_dwordx4 v[184:187], v2, s[44:47], s66 offen offset:2048 nt
    buffer_load_dwordx4 v[188:191], v2, s[44:47], s66 offen offset:3072 nt
    s_add_u32 s66, s66, 16384
    s_and_b32 s66, s66, 0xfffff
    s_add_u32 s67, s67, 1
    v_and_b32_dpp v20, v40, v8 row_newbcast:9 row_mask:0xf bank_mask:0xf
    v_and_b32_dpp v21, v40, v9 row_newbcast:9 row_mask:0xf bank_mask:0xf
    v_and_b32_dpp v22, v40, v10 row_newbcast:9 row_mask:0xf bank_mask:0xf
    v_and_b32_dpp v23, v40, v11 row_newbcast:9 row_mask:0xf bank_mask:0xf
    v_mfma_f32_16x16x32_bf16 v[12:15], v[16:19], v[160:163], v[12:15]
    v_and_b32_dpp v16, v40, v8 row_newbcast:5 row_mask:0xf bank_mask:0xf
    v_and_b32_dpp v17, v40, v9 row_newbcast:5 row_mask:0xf bank_mask:0xf
    v_and_b32_dpp v18, v40, v10 row_newbcast:5 row_mask:0xf bank_mask:0xf
    v_and_b32_dpp v19, v40, v11 row_newbcast:5 row_mask:0xf bank_mask:0xf
    v_mfma_f32_16x16x32_bf16 v[12:15], v[20:23], v[164:167], v[12:15]
    s_waitcnt vmcnt(4)
    s_cmp_eq_u32 s67, 64
    s_cselect_b32 s44, s64, s44
    s_cselect_b32 s45, s65, s45
    s_cmp_ge_u32 s67, 128
    s_cselect_b32 s46, 0, s46
    buffer_load_dwordx4 v[64:67], v2, s[44:47], s66 offen offset:0 nt
    buffer_load_dwordx4 v[68:71], v2, s[44:47], s66 offen offset:1024 nt
    v_and_b32_dpp v20, v40, v8 row_newbcast:13 row_mask:0xf bank_mask:0xf
    v_and_b32_dpp v21, v40, v9 row_newbcast:13 row_mask:0xf bank_mask:0xf
    v_and_b32_dpp v22, v40, v10 row_newbcast:13 row_mask:0xf bank_mask:0xf
    v_and_b32_dpp v23, v40, v11 row_newbcast:13 row_mask:0xf bank_mask:0xf
    v_mfma_f32_16x16x32_bf16 v[12:15], v[16:19], v[168:171], v[12:15]
    v_and_b32_dpp v16, v40, v8 row_newbcast:3 row_mask:0xf bank_mask:0xf
    v_and_b32_dpp v17, v40, v9 row_newbcast:3 row_mask:0xf bank_mask:0xf
    v_and_b32_dpp v18, v40, v10 row_newbcast:3 row_mask:0xf bank_mask:0xf
    v_and_b32_dpp v19, v40, v11 row_newbcast:3 row_mask:0xf bank_mask:0xf
    v_mfma_f32_16x16x32_bf16 v[12:15], v[20:23], v[172:175], v[12:15]
    s_waitcnt vmcnt(4)
    buffer_load_dwordx4 v[72:75], v2, s[44:47], s66 offen offset:2048 nt
    buffer_load_dwordx4 v[76:79], v2, s[44:47], s66 offen offset:3072 nt
    s_add_u32 s66, s66, 16384
    s_and_b32 s66, s66, 0xfffff
    s_add_u32 s67, s67, 1
    v_and_b32_dpp v20, v40, v8 row_newbcast:11 row_mask:0xf bank_mask:0xf
    v_and_b32_dpp v21, v40, v9 row_newbcast:11 row_mask:0xf bank_mask:0xf
    v_and_b32_dpp v22, v40, v10 row_newbcast:11 row_mask:0xf bank_mask:0xf
    v_and_b32_dpp v23, v40, v11 row_newbcast:11 row_mask:0xf bank_mask:0xf
    v_mfma_f32_16x16x32_bf16 v[12:15], v[16:19], v[176:179], v[12:15]
    v_and_b32_dpp v16, v40, v8 row_newbcast:7 row_mask:0xf bank_mask:0xf
    v_and_b32_dpp v17, v40, v9 row_newbcast:7 row_mask:0xf bank_mask:0xf
    v_and_b32_dpp v18, v40, v10 row_newbcast:7 row_mask:0xf bank_mask:0xf
    v_and_b32_dpp v19, v40, v11 row_newbcast:7 row_mask:0xf bank_mask:0xf
    v_mfma_f32_16x16x32_bf16 v[12:15], v[20:23], v[180:183], v[12:15]
    s_waitcnt vmcnt(4)
    s_cmp_eq_u32 s67, 64
    s_cselect_b32 s44, s64, s44
    s_cselect_b32 s45, s65, s45
    s_cmp_ge_u32 s67, 128
    s_cselect_b32 s46, 0, s46
    buffer_load_dwordx4 v[80:83], v2, s[44:47], s66 offen offset:0 nt
    buffer_load_dwordx4 v[84:87], v2, s[44:47], s66 offen offset:1024 nt
    v_and_b32_dpp v20, v40, v8 row_newbcast:15 row_mask:0xf bank_mask:0xf
    v_and_b32_dpp v21, v40, v9 row_newbcast:15 row_mask:0xf bank_mask:0xf
    v_and_b32_dpp v22, v40, v10 row_newbcast:15 row_mask:0xf bank_mask:0xf
    v_and_b32_dpp v23, v40, v11 row_newbcast:15 row_mask:0xf bank_mask:0xf
    v_mfma_f32_16x16x32_bf16 v[12:15], v[16:19], v[184:187], v[12:15]
    s_nop 1
    v_mfma_f32_16x16x32_bf16 v[12:15], v[20:23], v[188:191], v[12:15]
    s_sub_u32 s68, s68, 1
    s_cmp_lg_u32 s68, 0
    s_cbranch_scc1 L_vpass
    buffer_load_dwordx4 v[88:91], v2, s[44:47], s66 offen offset:2048 nt
    buffer_load_dwordx4 v[92:95], v2, s[44:47], s66 offen offset:3072 nt
    s_add_u32 s66, s66, 16384
    s_and_b32 s66, s66, 0xfffff
    s_add_u32 s67, s67, 1
    s_mov_b32 s68, 4
L_vpass2:
    s_waitcnt lgkmcnt(0)
    v_fma_f32 v46, v41, s87, v39
    v_add_u32 v42, 256, v42
    v_exp_f32 v46, v46
    ds_read_b32 v41, v42 offset:0
    v_cvt_pk_bf16_f32 v40, v46, v46
    v_add_f32 v38, v38, v46
    s_nop 0
    v_and_b32_dpp v16, v40, v8 row_newbcast:0 row_mask:0xf bank_mask:0xf
    v_and_b32_dpp v17, v40, v9 row_newbcast:0 row_mask:0xf bank_mask:0xf
    v_and_b32_dpp v18, v40, v10 row_newbcast:0 row_mask:0xf bank_mask:0xf
    v_and_b32_dpp v19, v40, v11 row_newbcast:0 row_mask:0xf bank_mask:0xf
    s_waitcnt vmcnt(6)
    s_cmp_eq_u32 s67, 64
    s_cselect_b32 s44, s64, s44
    s_cselect_b32 s45, s65, s45
    s_cmp_ge_u32 s67, 128
    s_cselect_b32 s46, 0, s46
    buffer_load_dwordx4 v[96:99], v2, s[44:47], s66 offen offset:0 nt
    buffer_load_dwordx4 v[100:103], v2, s[44:47], s66 offen offset:1024 nt
    v_and_b32_dpp v20, v40, v8 row_newbcast:8 row_mask:0xf bank_mask:0xf
    v_and_b32_dpp v21, v40, v9 row_newbcast:8 row_mask:0xf bank_mask:0xf
    v_and_b32_dpp v22, v40, v10 row_newbcast:8 row_mask:0xf bank_mask:0xf
    v_and_b32_dpp v23, v40, v11 row_newbcast:8 row_mask:0xf bank_mask:0xf
    v_mfma_f32_16x16x32_bf16 v[12:15], v[16:19], v[64:67], v[12:15]
    v_and_b32_dpp v16, v40, v8 row_newbcast:4 row_mask:0xf bank_mask:0xf
    v_and_b32_dpp v17, v40, v9 row_newbcast:4 row_mask:0xf bank_mask:0xf
    v_and_b32_dpp v18, v40, v10 row_newbcast:4 row_mask:0xf bank_mask:0xf
    v_and_b32_dpp v19, v40, v11 row_newbcast:4 row_mask:0xf bank_mask:0xf
    v_mfma_f32_16x16x32_bf16 v[12:15], v[20:23], v[68:71], v[12:15]
    s_waitcnt vmcnt(6)
    buffer_load_dwordx4 v[104:107], v2, s[44:47], s66 offen offset:2048 nt
    buffer_load_dwordx4 v[108:111], v2, s[44:47], s66 offen offset:3072 nt
    s_add_u32 s66, s66, 16384
    s_and_b32 s66, s66, 0xfffff
    s_add_u32 s67, s67, 1
    v_and_b32_dpp v20, v40, v8 row_newbcast:12 row_mask:0xf bank_mask:0xf
    v_and_b32_dpp v21, v40, v9 row_newbcast:12 row_mask:0xf bank_mask:0xf
    v_and_b32_dpp v22, v40, v10 row_newbcast:12 row_mask:0xf bank_mask:0xf
    v_and_b32_dpp v23, v40, v11 row_newbcast:12 row_mask:0xf bank_mask:0xf
    v_mfma_f32_16x16x32_bf16 v[12:15], v[16:19], v[72:75], v[12:15]
    v_and_b32_dpp v16, v40, v8 row_newbcast:2 row_mask:0xf bank_mask:0xf
    v_and_b32_dpp v17, v40, v9 row_newbcast:2 row_mask:0xf bank_mask:0xf
    v_and_b32_dpp v18, v40, v10 row_newbcast:2 row_mask:0xf bank_mask:0xf
    v_and_b32_dpp v19, v40, v11 row_newbcast:2 row_mask:0xf bank_mask:0xf
    v_mfma_f32_16x16x32_bf16 v[12:15], v[20:23], v[76:79], v[12:15]
    s_waitcnt vmcnt(6)
    s_cmp_eq_u32 s67, 64
    s_cselect_b32 s44, s64, s44
    s_cselect_b32 s45, s65, s45
    s_cmp_ge_u32 s67, 128
    s_cselect_b32 s46, 0, s46
    buffer_load_dwordx4 v[112:115], v2, s[44:47], s66 offen offset:0 nt
    buffer_load_dwordx4 v[116:119], v2, s[44:47], s66 offen offset:1024 nt
    v_and_b32_dpp v20, v40, v8 row_newbcast:10 row_mask:0xf bank_mask:0xf
    v_and_b32_dpp v21, v40, v9 row_newbcast:10 row_mask:0xf bank_mask:0xf
    v_and_b32_dpp v22, v40, v10 row_newbcast:10 row_mask:0xf bank_mask:0xf
    v_and_b32_dpp v23, v40, v11 row_newbcast:10 row_mask:0xf bank_mask:0xf
    v_mfma_f32_16x16x32_bf16 v[12:15], v[16:19], v[80:83], v[12:15]
    v_and_b32_dpp v16, v40, v8 row_newbcast:6 row_mask:0xf bank_mask:0xf
    v_and_b32_dpp v17, v40, v9 row_newbcast:6 row_mask:0xf bank_mask:0xf
    v_and_b32_dpp v18, v40, v10 row_newbcast:6 row_mask:0xf bank_mask:0xf
    v_and_b32_dpp v19, v40, v11 row_newbcast:6 row_mask:0xf bank_mask:0xf
    v_mfma_f32_16x16x32_bf16 v[12:15], v[20:23], v[84:87], v[12:15]
    s_waitcnt vmcnt(6)
    buffer_load_dwordx4 v[120:123], v2, s[44:47], s66 offen offset:2048 nt
    buffer_load_dwordx4 v[124:127], v2, s[44:47], s66 offen offset:3072 nt
    s_add_u32 s66, s66, 16384
    s_and_b32 s66, s66, 0xfffff
    s_add_u32 s67, s67, 1
    v_and_b32_dpp v20, v40, v8 row_newbcast:14 row_mask:0xf bank_mask:0xf
    v_and_b32_dpp v21, v40, v9 row_newbcast:14 row_mask:0xf bank_mask:0xf
    v_and_b32_dpp v22, v40, v10 row_newbcast:14 row_mask:0xf bank_mask:0xf
    v_and_b32_dpp v23, v40, v11 row_newbcast:14 row_mask:0xf bank_mask:0xf
    v_mfma_f32_16x16x32_bf16 v[12:15], v[16:19], v[88:91], v[12:15]
    v_and_b32_dpp v16, v40, v8 row_newbcast:1 row_mask:0xf bank_mask:0xf
    v_and_b32_dpp v17, v40, v9 row_newbcast:1 row_mask:0xf bank_mask:0xf
    v_and_b32_dpp v18, v40, v10 row_newbcast:1 row_mask:0xf bank_mask:0xf
    v_and_b32_dpp v19, v40, v11 row_newbcast:1 row_mask:0xf bank_mask:0xf
    v_mfma_f32_16x16x32_bf16 v[12:15], v[20:23], v[92:95], v[12:15]
    s_waitcnt vmcnt(6)
    s_cmp_eq_u32 s67, 64
    s_cselect_b32 s44, s64, s44
    s_cselect_b32 s45, s65, s45
    s_cmp_ge_u32 s67, 128
    s_cselect_b32 s46, 0, s46
    buffer_load_dwordx4 v[128:131], v2, s[44:47], s66 offen offset:0 nt
    buffer_load_dwordx4 v[132:135], v2, s[44:47], s66 offen offset:1024 nt
    v_and_b32_dpp v20, v40, v8 row_newbcast:9 row_mask:0xf bank_mask:0xf
    v_and_b32_dpp v21, v40, v9 row_newbcast:9 row_mask:0xf bank_mask:0xf
    v_and_b32_dpp v22, v40, v10 row_newbcast:9 row_mask:0xf bank_mask:0xf
    v_and_b32_dpp v23, v40, v11 row_newbcast:9 row_mask:0xf bank_mask:0xf
    v_mfma_f32_16x16x32_bf16 v[12:15], v[16:19], v[96:99], v[12:15]
    v_and_b32_dpp v16, v40, v8 row_newbcast:5 row_mask:0xf bank_mask:0xf
    v_and_b32_dpp v17, v40, v9 row_newbcast:5 row_mask:0xf bank_mask:0xf
    v_and_b32_dpp v18, v40, v10 row_newbcast:5 row_mask:0xf bank_mask:0xf
    v_and_b32_dpp v19, v40, v11 row_newbcast:5 row_mask:0xf bank_mask:0xf
    v_mfma_f32_16x16x32_bf16 v[12:15], v[20:23], v[100:103], v[12:15]
    s_waitcnt vmcnt(6)
    buffer_load_dwordx4 v[136:139], v2, s[44:47], s66 offen offset:2048 nt
    buffer_load_dwordx4 v[140:143], v2, s[44:47], s66 offen offset:3072 nt
    s_add_u32 s66, s66, 16384
    s_and_b32 s66, s66, 0xfffff
    s_add_u32 s67, s67, 1
    v_and_b32_dpp v20, v40, v8 row_newbcast:13 row_mask:0xf bank_mask:0xf
    v_and_b32_dpp v21, v40, v9 row_newbcast:13 row_mask:0xf bank_mask:0xf
    v_and_b32_dpp v22, v40, v10 row_newbcast:13 row_mask:0xf bank_mask:0xf
    v_and_b32_dpp v23, v40, v11 row_newbcast:13 row_mask:0xf bank_mask:0xf
    v_mfma_f32_16x16x32_bf16 v[12:15], v[16:19], v[104:107], v[12:15]
    v_and_b32_dpp v16, v40, v8 row_newbcast:3 row_mask:0xf bank_mask:0xf
    v_and_b32_dpp v17, v40, v9 row_newbcast:3 row_mask:0xf bank_mask:0xf
    v_and_b32_dpp v18, v40, v10 row_newbcast:3 row_mask:0xf bank_mask:0xf
    v_and_b32_dpp v19, v40, v11 row_newbcast:3 row_mask:0xf bank_mask:0xf
    v_mfma_f32_16x16x32_bf16 v[12:15], v[20:23], v[108:111], v[12:15]
    s_waitcnt vmcnt(6)
    s_cmp_eq_u32 s67, 64
    s_cselect_b32 s44, s64, s44
    s_cselect_b32 s45, s65, s45
    s_cmp_ge_u32 s67, 128
    s_cselect_b32 s46, 0, s46
    buffer_load_dwordx4 v[144:147], v2, s[44:47], s66 offen offset:0 nt
    buffer_load_dwordx4 v[148:151], v2, s[44:47], s66 offen offset:1024 nt
    v_and_b32_dpp v20, v40, v8 row_newbcast:11 row_mask:0xf bank_mask:0xf
    v_and_b32_dpp v21, v40, v9 row_newbcast:11 row_mask:0xf bank_mask:0xf
    v_and_b32_dpp v22, v40, v10 row_newbcast:11 row_mask:0xf bank_mask:0xf
    v_and_b32_dpp v23, v40, v11 row_newbcast:11 row_mask:0xf bank_mask:0xf
    v_mfma_f32_16x16x32_bf16 v[12:15], v[16:19], v[112:115], v[12:15]
    v_and_b32_dpp v16, v40, v8 row_newbcast:7 row_mask:0xf bank_mask:0xf
    v_and_b32_dpp v17, v40, v9 row_newbcast:7 row_mask:0xf bank_mask:0xf
    v_and_b32_dpp v18, v40, v10 row_newbcast:7 row_mask:0xf bank_mask:0xf
    v_and_b32_dpp v19, v40, v11 row_newbcast:7 row_mask:0xf bank_mask:0xf
    v_mfma_f32_16x16x32_bf16 v[12:15], v[20:23], v[116:119], v[12:15]
    s_waitcnt vmcnt(6)
    buffer_load_dwordx4 v[152:155], v2, s[44:47], s66 offen offset:2048 nt
    buffer_load_dwordx4 v[156:159], v2, s[44:47], s66 offen offset:3072 nt
    s_add_u32 s66, s66, 16384
    s_and_b32 s66, s66, 0xfffff
    s_add_u32 s67, s67, 1
    v_and_b32_dpp v20, v40, v8 row_newbcast:15 row_mask:0xf bank_mask:0xf
    v_and_b32_dpp v21, v40, v9 row_newbcast:15 row_mask:0xf bank_mask:0xf
    v_and_b32_dpp v22, v40, v10 row_newbcast:15 row_mask:0xf bank_mask:0xf
    v_and_b32_dpp v23, v40, v11 row_newbcast:15 row_mask:0xf bank_mask:0xf
    v_mfma_f32_16x16x32_bf16 v[12:15], v[16:19], v[120:123], v[12:15]
    s_nop 1
    v_mfma_f32_16x16x32_bf16 v[12:15], v[20:23], v[124:127], v[12:15]
    s_waitcnt lgkmcnt(0)
    v_fma_f32 v46, v41, s87, v39
    v_add_u32 v42, 256, v42
    v_exp_f32 v46, v46
    ds_read_b32 v41, v42 offset:0
    v_cvt_pk_bf16_f32 v40, v46, v46
    v_add_f32 v38, v38, v46
    s_nop 0
    v_and_b32_dpp v16, v40, v8 row_newbcast:0 row_mask:0xf bank_mask:0xf
    v_and_b32_dpp v17, v40, v9 row_newbcast:0 row_mask:0xf bank_mask:0xf
    v_and_b32_dpp v18, v40, v10 row_newbcast:0 row_mask:0xf bank_mask:0xf
    v_and_b32_dpp v19, v40, v11 row_newbcast:0 row_mask:0xf bank_mask:0xf
    s_waitcnt vmcnt(6)
    s_cmp_eq_u32 s67, 64
    s_cselect_b32 s44, s64, s44
    s_cselect_b32 s45, s65, s45
    s_cmp_ge_u32 s67, 128
    s_cselect_b32 s46, 0, s46
    buffer_load_dwordx4 v[160:163], v2, s[44:47], s66 offen offset:0 nt
    buffer_load_dwordx4 v[164:167], v2, s[44:47], s66 offen offset:1024 nt
    v_and_b32_dpp v20, v40, v8 row_newbcast:8 row_mask:0xf bank_mask:0xf
    v_and_b32_dpp v21, v40, v9 row_newbcast:8 row_mask:0xf bank_mask:0xf
    v_and_b32_dpp v22, v40, v10 row_newbcast:8 row_mask:0xf bank_mask:0xf
    v_and_b32_dpp v23, v40, v11 row_newbcast:8 row_mask:0xf bank_mask:0xf
    v_mfma_f32_16x16x32_bf16 v[12:15], v[16:19], v[128:131], v[12:15]
    v_and_b32_dpp v16, v40, v8 row_newbcast:4 row_mask:0xf bank_mask:0xf
    v_and_b32_dpp v17, v40, v9 row_newbcast:4 row_mask:0xf bank_mask:0xf
    v_and_b32_dpp v18, v40, v10 row_newbcast:4 row_mask:0xf bank_mask:0xf
    v_and_b32_dpp v19, v40, v11 row_newbcast:4 row_mask:0xf bank_mask:0xf
    v_mfma_f32_16x16x32_bf16 v[12:15], v[20:23], v[132:135], v[12:15]
    s_waitcnt vmcnt(6)
    buffer_load_dwordx4 v[168:171], v2, s[44:47], s66 offen offset:2048 nt
    buffer_load_dwordx4 v[172:175], v2, s[44:47], s66 offen offset:3072 nt
    s_add_u32 s66, s66, 16384
    s_and_b32 s66, s66, 0xfffff
    s_add_u32 s67, s67, 1
    v_and_b32_dpp v20, v40, v8 row_newbcast:12 row_mask:0xf bank_mask:0xf
    v_and_b32_dpp v21, v40, v9 row_newbcast:12 row_mask:0xf bank_mask:0xf
    v_and_b32_dpp v22, v40, v10 row_newbcast:12 row_mask:0xf bank_mask:0xf
    v_and_b32_dpp v23, v40, v11 row_newbcast:12 row_mask:0xf bank_mask:0xf
    v_mfma_f32_16x16x32_bf16 v[12:15], v[16:19], v[136:139], v[12:15]
    v_and_b32_dpp v16, v40, v8 row_newbcast:2 row_mask:0xf bank_mask:0xf
    v_and_b32_dpp v17, v40, v9 row_newbcast:2 row_mask:0xf bank_mask:0xf
    v_and_b32_dpp v18, v40, v10 row_newbcast:2 row_mask:0xf bank_mask:0xf
    v_and_b32_dpp v19, v40, v11 row_newbcast:2 row_mask:0xf bank_mask:0xf
    v_mfma_f32_16x16x32_bf16 v[12:15], v[20:23], v[140:143], v[12:15]
    s_waitcnt vmcnt(6)
    s_cmp_eq_u32 s67, 64
    s_cselect_b32 s44, s64, s44
    s_cselect_b32 s45, s65, s45
    s_cmp_ge_u32 s67, 128
    s_cselect_b32 s46, 0, s46
    buffer_load_dwordx4 v[176:179], v2, s[44:47], s66 offen offset:0 nt
    buffer_load_dwordx4 v[180:183], v2, s[44:47], s66 offen offset:1024 nt
    v_and_b32_dpp v20, v40, v8 row_newbcast:10 row_mask:0xf bank_mask:0xf
    v_and_b32_dpp v21, v40, v9 row_newbcast:10 row_mask:0xf bank_mask:0xf
    v_and_b32_dpp v22, v40, v10 row_newbcast:10 row_mask:0xf bank_mask:0xf
    v_and_b32_dpp v23, v40, v11 row_newbcast:10 row_mask:0xf bank_mask:0xf
    v_mfma_f32_16x16x32_bf16 v[12:15], v[16:19], v[144:147], v[12:15]
    v_and_b32_dpp v16, v40, v8 row_newbcast:6 row_mask:0xf bank_mask:0xf
    v_and_b32_dpp v17, v40, v9 row_newbcast:6 row_mask:0xf bank_mask:0xf
    v_and_b32_dpp v18, v40, v10 row_newbcast:6 row_mask:0xf bank_mask:0xf
    v_and_b32_dpp v19, v40, v11 row_newbcast:6 row_mask:0xf bank_mask:0xf
    v_mfma_f32_16x16x32_bf16 v[12:15], v[20:23], v[148:151], v[12:15]
    s_waitcnt vmcnt(6)
    buffer_load_dwordx4 v[184:187], v2, s[44:47], s66 offen offset:2048 nt
    buffer_load_dwordx4 v[188:191], v2, s[44:47], s66 offen offset:3072 nt
    s_add_u32 s66, s66, 16384
    s_and_b32 s66, s66, 0xfffff
    s_add_u32 s67, s67, 1
    v_and_b32_dpp v20, v40, v8 row_newbcast:14 row_mask:0xf bank_mask:0xf
    v_and_b32_dpp v21, v40, v9 row_newbcast:14 row_mask:0xf bank_mask:0xf
    v_and_b32_dpp v22, v40, v10 row_newbcast:14 row_mask:0xf bank_mask:0xf
    v_and_b32_dpp v23, v40, v11 row_newbcast:14 row_mask:0xf bank_mask:0xf
    v_mfma_f32_16x16x32_bf16 v[12:15], v[16:19], v[152:155], v[12:15]
    v_and_b32_dpp v16, v40, v8 row_newbcast:1 row_mask:0xf bank_mask:0xf
    v_and_b32_dpp v17, v40, v9 row_newbcast:1 row_mask:0xf bank_mask:0xf
    v_and_b32_dpp v18, v40, v10 row_newbcast:1 row_mask:0xf bank_mask:0xf
    v_and_b32_dpp v19, v40, v11 row_newbcast:1 row_mask:0xf bank_mask:0xf
    v_mfma_f32_16x16x32_bf16 v[12:15], v[20:23], v[156:159], v[12:15]
    s_waitcnt vmcnt(6)
    s_cmp_eq_u32 s67, 64
    s_cselect_b32 s44, s64, s44
    s_cselect_b32 s45, s65, s45
    s_cmp_ge_u32 s67, 128
    s_cselect_b32 s46, 0, s46
    buffer_load_dwordx4 v[64:67], v2, s[44:47], s66 offen offset:0 nt
    buffer_load_dwordx4 v[68:71], v2, s[44:47], s66 offen offset:1024 nt
    v_and_b32_dpp v20, v40, v8 row_newbcast:9 row_mask:0xf bank_mask:0xf
    v_and_b32_dpp v21, v40, v9 row_newbcast:9 row_mask:0xf bank_mask:0xf
    v_and_b32_dpp v22, v40, v10 row_newbcast:9 row_mask:0xf bank_mask:0xf
    v_and_b32_dpp v23, v40, v11 row_newbcast:9 row_mask:0xf bank_mask:0xf
    v_mfma_f32_16x16x32_bf16 v[12:15], v[16:19], v[160:163], v[12:15]
    v_and_b32_dpp v16, v40, v8 row_newbcast:5 row_mask:0xf bank_mask:0xf
    v_and_b32_dpp v17, v40, v9 row_newbcast:5 row_mask:0xf bank_mask:0xf
    v_and_b32_dpp v18, v40, v10 row_newbcast:5 row_mask:0xf bank_mask:0xf
    v_and_b32_dpp v19, v40, v11 row_newbcast:5 row_mask:0xf bank_mask:0xf
    v_mfma_f32_16x16x32_bf16 v[12:15], v[20:23], v[164:167], v[12:15]
    s_waitcnt vmcnt(6)
    buffer_load_dwordx4 v[72:75], v2, s[44:47], s66 offen offset:2048 nt
    buffer_load_dwordx4 v[76:79], v2, s[44:47], s66 offen offset:3072 nt
    s_add_u32 s66, s66, 16384
    s_and_b32 s66, s66, 0xfffff
    s_add_u32 s67, s67, 1
    v_and_b32_dpp v20, v40, v8 row_newbcast:13 row_mask:0xf bank_mask:0xf
    v_and_b32_dpp v21, v40, v9 row_newbcast:13 row_mask:0xf bank_mask:0xf
    v_and_b32_dpp v22, v40, v10 row_newbcast:13 row_mask:0xf bank_mask:0xf
    v_and_b32_dpp v23, v40, v11 row_newbcast:13 row_mask:0xf bank_mask:0xf
    v_mfma_f32_16x16x32_bf16 v[12:15], v[16:19], v[168:171], v[12:15]
    v_and_b32_dpp v16, v40, v8 row_newbcast:3 row_mask:0xf bank_mask:0xf
    v_and_b32_dpp v17, v40, v9 row_newbcast:3 row_mask:0xf bank_mask:0xf
    v_and_b32_dpp v18, v40, v10 row_newbcast:3 row_mask:0xf bank_mask:0xf
    v_and_b32_dpp v19, v40, v11 row_newbcast:3 row_mask:0xf bank_mask:0xf
    v_mfma_f32_16x16x32_bf16 v[12:15], v[20:23], v[172:175], v[12:15]
    s_waitcnt vmcnt(6)
    s_cmp_eq_u32 s67, 64
    s_cselect_b32 s44, s64, s44
    s_cselect_b32 s45, s65, s45
    s_cmp_ge_u32 s67, 128
    s_cselect_b32 s46, 0, s46
    buffer_load_dwordx4 v[80:83], v2, s[44:47], s66 offen offset:0 nt
    buffer_load_dwordx4 v[84:87], v2, s[44:47], s66 offen offset:1024 nt
    v_and_b32_dpp v20, v40, v8 row_newbcast:11 row_mask:0xf bank_mask:0xf
    v_and_b32_dpp v21, v40, v9 row_newbcast:11 row_mask:0xf bank_mask:0xf
    v_and_b32_dpp v22, v40, v10 row_newbcast:11 row_mask:0xf bank_mask:0xf
    v_and_b32_dpp v23, v40, v11 row_newbcast:11 row_mask:0xf bank_mask:0xf
    v_mfma_f32_16x16x32_bf16 v[12:15], v[16:19], v[176:179], v[12:15]
    v_and_b32_dpp v16, v40, v8 row_newbcast:7 row_mask:0xf bank_mask:0xf
    v_and_b32_dpp v17, v40, v9 row_newbcast:7 row_mask:0xf bank_mask:0xf
    v_and_b32_dpp v18, v40, v10 row_newbcast:7 row_mask:0xf bank_mask:0xf
    v_and_b32_dpp v19, v40, v11 row_newbcast:7 row_mask:0xf bank_mask:0xf
    v_mfma_f32_16x16x32_bf16 v[12:15], v[20:23], v[180:183], v[12:15]
    s_waitcnt vmcnt(6)
    buffer_load_dwordx4 v[88:91], v2, s[44:47], s66 offen offset:2048 nt
    buffer_load_dwordx4 v[92:95], v2, s[44:47], s66 offen offset:3072 nt
    s_add_u32 s66, s66, 16384
    s_and_b32 s66, s66, 0xfffff
    s_add_u32 s67, s67, 1
    v_and_b32_dpp v20, v40, v8 row_newbcast:15 row_mask:0xf bank_mask:0xf
    v_and_b32_dpp v21, v40, v9 row_newbcast:15 row_mask:0xf bank_mask:0xf
    v_and_b32_dpp v22, v40, v10 row_newbcast:15 row_mask:0xf bank_mask:0xf
    v_and_b32_dpp v23, v40, v11 row_newbcast:15 row_mask:0xf bank_mask:0xf
    v_mfma_f32_16x16x32_bf16 v[12:15], v[16:19], v[184:187], v[12:15]
    s_nop 1
    v_mfma_f32_16x16x32_bf16 v[12:15], v[20:23], v[188:191], v[12:15]
    s_sub_u32 s68, s68, 1
    s_cmp_lg_u32 s68, 0
    s_cbranch_scc1 L_vpass2
    s_cmp_lg_u32 s30, 0
    s_cbranch_scc1 L_yb_out
    s_mov_b32 exec_lo, 0
    buffer_store_dwordx4 v[48:51], v43, s[36:39], 0 offen sc1
    buffer_store_dwordx4 v[52:55], v43, s[36:39], 0 offen offset:16 sc1
    s_mov_b32 exec_lo, -1
L_yb_out:
    v_add_f32_dpp v38, v38, v38 row_ror:8 row_mask:0xf bank_mask:0xf
    s_nop 1
    v_add_f32_dpp v38, v38, v38 row_ror:4 row_mask:0xf bank_mask:0xf
    s_nop 1
    v_add_f32_dpp v38, v38, v38 row_ror:2 row_mask:0xf bank_mask:0xf
    s_nop 1
    v_add_f32_dpp v38, v38, v38 row_ror:1 row_mask:0xf bank_mask:0xf
    v_mov_b32 v46, v38
    s_nop 1
    v_permlane16_swap_b32 v38, v46
    v_add_f32 v38, v38, v46
    v_mov_b32 v46, v38
    s_nop 1
    v_permlane32_swap_b32 v38, v46
    v_add_f32 v38, v38, v46
    v_lshlrev_b32 v46, 5, v45
    v_lshl_add_u32 v46, v44, 4, v46
    s_mul_i32 s69, s30, 528
    v_add_u32 v46, s69, v46
    v_mov_b32 v47, s69
    s_mov_b32 exec_hi, 0
    ds_write_b128 v46, v[12:15] offset:22016
    s_mov_b32 exec_hi, -1
    v_mov_b32 v16, v37
    v_mov_b32 v17, v38
    ds_write_b64 v47, v[16:17] offset:22528
    s_waitcnt lgkmcnt(0)
    s_barrier
    v_and_b32 v46, 31, v1
    s_lshl_b32 s69, s30, 7
    v_lshl_add_u32 v46, v46, 2, s69
    v_mov_b32 v47, 0
    ds_read_b32 v24, v46 offset:22016
    ds_read_b64 v[16:17], v47 offset:22528
    ds_read_b32 v25, v46 offset:22544
    ds_read_b64 v[18:19], v47 offset:23056
    ds_read_b32 v26, v46 offset:23072
    ds_read_b64 v[20:21], v47 offset:23584
    ds_read_b32 v27, v46 offset:23600
    ds_read_b64 v[22:23], v47 offset:24112
    s_waitcnt lgkmcnt(0)
    v_max_f32 v28, v16, v18
    v_max3_f32 v28, v28, v20, v22
    v_sub_f32 v16, v16, v28
    v_mul_f32 v16, s87, v16
    v_exp_f32 v16, v16
    v_sub_f32 v18, v18, v28
    v_mul_f32 v18, s87, v18
    v_exp_f32 v18, v18
    v_sub_f32 v20, v20, v28
    v_mul_f32 v20, s87, v20
    v_exp_f32 v20, v20
    v_sub_f32 v22, v22, v28
    v_mul_f32 v22, s87, v22
    v_exp_f32 v22, v22
    v_mul_f32 v30, v16, v24
    v_mul_f32 v29, v16, v17
    v_fmac_f32 v30, v18, v25
    v_fmac_f32 v29, v18, v19
    v_fmac_f32 v30, v20, v26
    v_fmac_f32 v29, v20, v21
    v_fmac_f32 v30, v22, v27
    v_fmac_f32 v29, v22, v23
    v_mov_b32 v31, v59
    v_mov_b32 v32, v28
    v_mov_b32 v33, v59
    v_mov_b32 v34, v29
    v_mov_b32 v35, v59
    s_lshl_b32 s69, s5, 11
    v_lshl_add_u32 v46, v46, 1, s69
    s_add_u32 s70, s69, 1024
    v_mov_b32 v47, s70
    s_mov_b32 exec_hi, 0
    buffer_store_dwordx2 v[30:31], v46, s[36:39], 0 offen sc1
    s_mov_b64 exec, 1
    buffer_store_dwordx4 v[32:35], v47, s[36:39], 0 offen sc1
    s_mov_b64 exec, -1
    v_and_b32 v46, 7, v45
    v_lshlrev_b32 v46, 5, v46
    v_lshl_add_u32 v46, v44, 3, v46
    s_lshl_b32 s69, s31, 14
    s_lshl_b32 s70, s30, 8
    s_add_u32 s70, s70, s69
    v_add_u32 v46, s70, v46
    v_and_b32 v47, 7, v1
    v_lshlrev_b32 v47, 11, v47
    s_add_u32 s69, s69, 1024
    v_add_u32 v47, s69, v47
    s_mov_b32 s73, 200000
L_h1:
    s_mov_b32 s69, 0
    buffer_load_dwordx2 v[16:17], v46, s[36:39], s69 offen offset:0 sc1
    buffer_load_dwordx2 v[18:19], v46, s[36:39], s69 offen offset:2048 sc1
    s_mov_b32 s69, 4096
    buffer_load_dwordx2 v[20:21], v46, s[36:39], s69 offen offset:0 sc1
    buffer_load_dwordx2 v[22:23], v46, s[36:39], s69 offen offset:2048 sc1
    s_mov_b32 s69, 8192
    buffer_load_dwordx2 v[24:25], v46, s[36:39], s69 offen offset:0 sc1
    buffer_load_dwordx2 v[26:27], v46, s[36:39], s69 offen offset:2048 sc1
    s_mov_b32 s69, 12288
    buffer_load_dwordx2 v[28:29], v46, s[36:39], s69 offen offset:0 sc1
    buffer_load_dwordx2 v[30:31], v46, s[36:39], s69 offen offset:2048 sc1
    buffer_load_dwordx4 v[32:35], v47, s[36:39], 0 offen sc1
    s_waitcnt vmcnt(0)
    v_min3_u32 v57, v17, v19, v59
    v_min3_u32 v57, v57, v21, v23
    v_min3_u32 v57, v57, v25, v27
    v_min3_u32 v57, v57, v29, v31
    v_min3_u32 v57, v57, v33, v35
    v_max3_u32 v58, v17, v19, v59
    v_max3_u32 v58, v58, v21, v23
    v_max3_u32 v58, v58, v25, v27
    v_max3_u32 v58, v58, v29, v31
    v_max3_u32 v58, v58, v33, v35
    v_cmp_ne_u32 vcc, v57, v58
    s_nop 0
    s_cbranch_vccz L_h1_ok
    s_sub_u32 s73, s73, 1
    s_cmp_eq_u32 s73, 0
    s_cbranch_scc1 L_h1_ok
    s_branch L_h1
L_h1_ok:
    v_mov_b32 v84, v32
    s_nop 1
    v_max_f32_dpp v84, v84, v84 row_ror:4 row_mask:0xf bank_mask:0xf
    s_nop 1
    v_max_f32_dpp v84, v84, v84 row_ror:2 row_mask:0xf bank_mask:0xf
    s_nop 1
    v_max_f32_dpp v84, v84, v84 row_ror:1 row_mask:0xf bank_mask:0xf
    v_sub_f32 v84, v32, v84
    v_mul_f32 v84, s87, v84
    v_exp_f32 v84, v84
    s_nop 0
    v_mul_f32 v85, v84, v34
    v_mul_f32_dpp v86, v84, v16 row_newbcast:0 row_mask:0xf bank_mask:0xf
    v_mul_f32_dpp v87, v84, v18 row_newbcast:1 row_mask:0xf bank_mask:0xf
    v_add_f32_dpp v85, v85, v85 row_ror:4 row_mask:0xf bank_mask:0xf
    v_mul_f32_dpp v88, v84, v20 row_newbcast:2 row_mask:0xf bank_mask:0xf
    v_fmac_f32_dpp v86, v84, v22 row_newbcast:3 row_mask:0xf bank_mask:0xf
    v_fmac_f32_dpp v87, v84, v24 row_newbcast:4 row_mask:0xf bank_mask:0xf
    v_add_f32_dpp v85, v85, v85 row_ror:2 row_mask:0xf bank_mask:0xf
    v_fmac_f32_dpp v88, v84, v26 row_newbcast:5 row_mask:0xf bank_mask:0xf
    v_fmac_f32_dpp v86, v84, v28 row_newbcast:6 row_mask:0xf bank_mask:0xf
    v_fmac_f32_dpp v87, v84, v30 row_newbcast:7 row_mask:0xf bank_mask:0xf
    v_add_f32_dpp v85, v85, v85 row_ror:1 row_mask:0xf bank_mask:0xf
    v_add_f32 v86, v86, v87
    v_rcp_f32 v87, v85
    v_add_f32 v86, v86, v88
    v_fma_f32 v88, -v85, v87, 1.0
    v_fma_f32 v87, v88, v87, v87
    v_mul_f32 v88, v86, v87
    v_fma_f32 v84, -v88, v85, v86
    v_fma_f32 v88, v84, v87, v88
    v_cvt_pk_bf16_f32 v40, v88, v88
    s_nop 1
    v_and_b32_dpp v92, v40, v8 row_newbcast:0 row_mask:0xf bank_mask:0xf
    v_and_b32_dpp v93, v40, v9 row_newbcast:0 row_mask:0xf bank_mask:0xf
    v_and_b32_dpp v94, v40, v10 row_newbcast:0 row_mask:0xf bank_mask:0xf
    v_and_b32_dpp v95, v40, v11 row_newbcast:0 row_mask:0xf bank_mask:0xf
    s_nop 1
    v_mfma_f32_16x16x32_bf16 v[12:15], v[92:95], v[192:195], 0
    v_and_b32_dpp v96, v40, v8 row_newbcast:1 row_mask:0xf bank_mask:0xf
    v_and_b32_dpp v97, v40, v9 row_newbcast:1 row_mask:0xf bank_mask:0xf
    v_and_b32_dpp v98, v40, v10 row_newbcast:1 row_mask:0xf bank_mask:0xf
    v_and_b32_dpp v99, v40, v11 row_newbcast:1 row_mask:0xf bank_mask:0xf
    s_nop 1
    v_mfma_f32_16x16x32_bf16 v[12:15], v[96:99], v[196:199], v[12:15]
    v_and_b32_dpp v92, v40, v8 row_newbcast:2 row_mask:0xf bank_mask:0xf
    v_and_b32_dpp v93, v40, v9 row_newbcast:2 row_mask:0xf bank_mask:0xf
    v_and_b32_dpp v94, v40, v10 row_newbcast:2 row_mask:0xf bank_mask:0xf
    v_and_b32_dpp v95, v40, v11 row_newbcast:2 row_mask:0xf bank_mask:0xf
    s_nop 1
    v_mfma_f32_16x16x32_bf16 v[12:15], v[92:95], v[200:203], v[12:15]
    v_and_b32_dpp v96, v40, v8 row_newbcast:3 row_mask:0xf bank_mask:0xf
    v_and_b32_dpp v97, v40, v9 row_newbcast:3 row_mask:0xf bank_mask:0xf
    v_and_b32_dpp v98, v40, v10 row_newbcast:3 row_mask:0xf bank_mask:0xf
    v_and_b32_dpp v99, v40, v11 row_newbcast:3 row_mask:0xf bank_mask:0xf
    s_nop 1
    v_mfma_f32_16x16x32_bf16 v[12:15], v[96:99], v[204:207], v[12:15]
    v_and_b32_dpp v92, v40, v8 row_newbcast:4 row_mask:0xf bank_mask:0xf
    v_and_b32_dpp v93, v40, v9 row_newbcast:4 row_mask:0xf bank_mask:0xf
    v_and_b32_dpp v94, v40, v10 row_newbcast:4 row_mask:0xf bank_mask:0xf
    v_and_b32_dpp v95, v40, v11 row_newbcast:4 row_mask:0xf bank_mask:0xf
    s_nop 1
    v_mfma_f32_16x16x32_bf16 v[12:15], v[92:95], v[208:211], v[12:15]
    v_and_b32_dpp v96, v40, v8 row_newbcast:5 row_mask:0xf bank_mask:0xf
    v_and_b32_dpp v97, v40, v9 row_newbcast:5 row_mask:0xf bank_mask:0xf
    v_and_b32_dpp v98, v40, v10 row_newbcast:5 row_mask:0xf bank_mask:0xf
    v_and_b32_dpp v99, v40, v11 row_newbcast:5 row_mask:0xf bank_mask:0xf
    s_nop 1
    v_mfma_f32_16x16x32_bf16 v[12:15], v[96:99], v[212:215], v[12:15]
    v_and_b32_dpp v92, v40, v8 row_newbcast:6 row_mask:0xf bank_mask:0xf
    v_and_b32_dpp v93, v40, v9 row_newbcast:6 row_mask:0xf bank_mask:0xf
    v_and_b32_dpp v94, v40, v10 row_newbcast:6 row_mask:0xf bank_mask:0xf
    v_and_b32_dpp v95, v40, v11 row_newbcast:6 row_mask:0xf bank_mask:0xf
    s_nop 1
    v_mfma_f32_16x16x32_bf16 v[12:15], v[92:95], v[216:219], v[12:15]
    v_and_b32_dpp v96, v40, v8 row_newbcast:7 row_mask:0xf bank_mask:0xf
    v_and_b32_dpp v97, v40, v9 row_newbcast:7 row_mask:0xf bank_mask:0xf
    v_and_b32_dpp v98, v40, v10 row_newbcast:7 row_mask:0xf bank_mask:0xf
    v_and_b32_dpp v99, v40, v11 row_newbcast:7 row_mask:0xf bank_mask:0xf
    s_nop 1
    v_mfma_f32_16x16x32_bf16 v[12:15], v[96:99], v[220:223], v[12:15]
    v_lshlrev_b32 v46, 5, v45
    v_lshl_add_u32 v46, v44, 4, v46
    s_lshl_b32 s69, s30, 9
    v_add_u32 v46, s69, v46
    s_mov_b32 exec_hi, 0
    s_nop 2
    ds_write_b128 v46, v[12:15] offset:24128
    s_mov_b32 exec_hi, -1
    s_waitcnt lgkmcnt(0)
    s_barrier
    s_cmp_lg_u32 s30, 0
    s_cbranch_scc1 L_end
    v_and_b32 v46, 31, v1
    v_lshlrev_b32 v46, 4, v46
    ds_read_b128 v[100:103], v46 offset:24128
    ds_read_b128 v[104:107], v46 offset:24640
    ds_read_b128 v[108:111], v46 offset:25152
    ds_read_b128 v[112:115], v46 offset:25664
    s_waitcnt lgkmcnt(0)
    v_add_f32 v100, v100, v104
    v_add_f32 v108, v108, v112
    v_add_f32 v101, v101, v105
    v_add_f32 v109, v109, v113
    v_add_f32 v102, v102, v106
    v_add_f32 v110, v110, v114
    v_add_f32 v103, v103, v107
    v_add_f32 v111, v111, v115
    v_add_f32 v48, v100, v108
    v_mov_b32 v49, v59
    v_add_f32 v50, v101, v109
    v_mov_b32 v51, v59
    v_add_f32 v52, v102, v110
    v_mov_b32 v53, v59
    v_add_f32 v54, v103, v111
    v_mov_b32 v55, v59
    s_mov_b32 exec_hi, 0
    buffer_store_dwordx4 v[48:51], v43, s[36:39], 0 offen sc1
    buffer_store_dwordx4 v[52:55], v43, s[36:39], 0 offen offset:16 sc1
    s_mov_b32 exec_hi, -1
    s_cmp_lg_u32 s4, 0
    s_cbranch_scc1 L_end
    s_cmp_ge_u32 s31, 9
    s_cbranch_scc1 L_end
    s_mov_b32 s60, s24
    s_and_b32 s61, s25, 0xffff
    s_mov_b32 s62, 1152
    s_mov_b32 s63, 0x20000
    s_lshl_b32 s69, s31, 9
    v_lshl_add_u32 v46, v45, 5, s69
    v_mul_u32_u24 v47, 4608, v44
    v_add_u32 v46, v46, v47
    s_lshl_b32 s69, s31, 7
    v_lshl_add_u32 v47, v45, 3, s69
    buffer_load_dwordx2 v[4:5], v47, s[32:35], 0 offen
    s_mov_b32 s69, 1769472
    buffer_load_dwordx4 v[64:67], v46, s[36:39], s69 offen sc1
    buffer_load_dwordx4 v[68:71], v46, s[36:39], s69 offen offset:16 sc1
    s_mov_b32 s69, 1787904
    buffer_load_dwordx4 v[72:75], v46, s[36:39], s69 offen sc1
    buffer_load_dwordx4 v[76:79], v46, s[36:39], s69 offen offset:16 sc1
    s_mov_b32 s69, 1806336
    buffer_load_dwordx4 v[80:83], v46, s[36:39], s69 offen sc1
    buffer_load_dwordx4 v[84:87], v46, s[36:39], s69 offen offset:16 sc1
    s_mov_b32 s69, 1824768
    buffer_load_dwordx4 v[88:91], v46, s[36:39], s69 offen sc1
    buffer_load_dwordx4 v[92:95], v46, s[36:39], s69 offen offset:16 sc1
    s_mov_b32 s69, 1843200
    buffer_load_dwordx4 v[96:99], v46, s[36:39], s69 offen sc1
    buffer_load_dwordx4 v[100:103], v46, s[36:39], s69 offen offset:16 sc1
    s_mov_b32 s69, 1861632
    buffer_load_dwordx4 v[104:107], v46, s[36:39], s69 offen sc1
    buffer_load_dwordx4 v[108:111], v46, s[36:39], s69 offen offset:16 sc1
    s_mov_b32 s69, 1880064
    buffer_load_dwordx4 v[112:115], v46, s[36:39], s69 offen sc1
    buffer_load_dwordx4 v[116:119], v46, s[36:39], s69 offen offset:16 sc1
    s_mov_b32 s69, 1898496
    buffer_load_dwordx4 v[120:123], v46, s[36:39], s69 offen sc1
    buffer_load_dwordx4 v[124:127], v46, s[36:39], s69 offen offset:16 sc1
    s_mov_b32 s69, 1572864
    buffer_load_dwordx4 v[128:131], v46, s[36:39], s69 offen sc1
    buffer_load_dwordx4 v[132:135], v46, s[36:39], s69 offen offset:16 sc1
    s_mov_b32 s69, 1591296
    buffer_load_dwordx4 v[136:139], v46, s[36:39], s69 offen sc1
    buffer_load_dwordx4 v[140:143], v46, s[36:39], s69 offen offset:16 sc1
    s_mov_b32 s69, 1609728
    buffer_load_dwordx4 v[144:147], v46, s[36:39], s69 offen sc1
    buffer_load_dwordx4 v[148:151], v46, s[36:39], s69 offen offset:16 sc1
    s_mov_b32 s69, 1628160
    buffer_load_dwordx4 v[152:155], v46, s[36:39], s69 offen sc1
    buffer_load_dwordx4 v[156:159], v46, s[36:39], s69 offen offset:16 sc1
    s_mov_b32 s69, 1646592
    buffer_load_dwordx4 v[160:163], v46, s[36:39], s69 offen sc1
    buffer_load_dwordx4 v[164:167], v46, s[36:39], s69 offen offset:16 sc1
    s_mov_b32 s69, 1665024
    buffer_load_dwordx4 v[168:171], v46, s[36:39], s69 offen sc1
    buffer_load_dwordx4 v[172:175], v46, s[36:39], s69 offen offset:16 sc1
    s_mov_b32 s69, 1683456
    buffer_load_dwordx4 v[176:179], v46, s[36:39], s69 offen sc1
    buffer_load_dwordx4 v[180:183], v46, s[36:39], s69 offen offset:16 sc1
    s_mov_b32 s69, 1701888
    buffer_load_dwordx4 v[184:187], v46, s[36:39], s69 offen sc1
    buffer_load_dwordx4 v[188:191], v46, s[36:39], s69 offen offset:16 sc1
    s_waitcnt vmcnt(16)
    s_mov_b32 s73, 200000
    s_branch L_gb_t
L_gb:
    s_mov_b32 s69, 1769472
    buffer_load_dwordx4 v[64:67], v46, s[36:39], s69 offen sc1
    buffer_load_dwordx4 v[68:71], v46, s[36:39], s69 offen offset:16 sc1
    s_mov_b32 s69, 1787904
    buffer_load_dwordx4 v[72:75], v46, s[36:39], s69 offen sc1
    buffer_load_dwordx4 v[76:79], v46, s[36:39], s69 offen offset:16 sc1
    s_mov_b32 s69, 1806336
    buffer_load_dwordx4 v[80:83], v46, s[36:39], s69 offen sc1
    buffer_load_dwordx4 v[84:87], v46, s[36:39], s69 offen offset:16 sc1
    s_mov_b32 s69, 1824768
    buffer_load_dwordx4 v[88:91], v46, s[36:39], s69 offen sc1
    buffer_load_dwordx4 v[92:95], v46, s[36:39], s69 offen offset:16 sc1
    s_mov_b32 s69, 1843200
    buffer_load_dwordx4 v[96:99], v46, s[36:39], s69 offen sc1
    buffer_load_dwordx4 v[100:103], v46, s[36:39], s69 offen offset:16 sc1
    s_mov_b32 s69, 1861632
    buffer_load_dwordx4 v[104:107], v46, s[36:39], s69 offen sc1
    buffer_load_dwordx4 v[108:111], v46, s[36:39], s69 offen offset:16 sc1
    s_mov_b32 s69, 1880064
    buffer_load_dwordx4 v[112:115], v46, s[36:39], s69 offen sc1
    buffer_load_dwordx4 v[116:119], v46, s[36:39], s69 offen offset:16 sc1
    s_mov_b32 s69, 1898496
    buffer_load_dwordx4 v[120:123], v46, s[36:39], s69 offen sc1
    buffer_load_dwordx4 v[124:127], v46, s[36:39], s69 offen offset:16 sc1
    s_waitcnt vmcnt(0)
L_gb_t:
    v_min3_u32 v57, v65, v67, v59
    v_min3_u32 v57, v57, v69, v71
    v_min3_u32 v57, v57, v73, v75
    v_min3_u32 v57, v57, v77, v79
    v_min3_u32 v57, v57, v81, v83
    v_min3_u32 v57, v57, v85, v87
    v_min3_u32 v57, v57, v89, v91
    v_min3_u32 v57, v57, v93, v95
    v_min3_u32 v57, v57, v97, v99
    v_min3_u32 v57, v57, v101, v103
    v_min3_u32 v57, v57, v105, v107
    v_min3_u32 v57, v57, v109, v111
    v_min3_u32 v57, v57, v113, v115
    v_min3_u32 v57, v57, v117, v119
    v_min3_u32 v57, v57, v121, v123
    v_min3_u32 v57, v57, v125, v127
    v_max3_u32 v58, v65, v67, v59
    v_max3_u32 v58, v58, v69, v71
    v_max3_u32 v58, v58, v73, v75
    v_max3_u32 v58, v58, v77, v79
    v_max3_u32 v58, v58, v81, v83
    v_max3_u32 v58, v58, v85, v87
    v_max3_u32 v58, v58, v89, v91
    v_max3_u32 v58, v58, v93, v95
    v_max3_u32 v58, v58, v97, v99
    v_max3_u32 v58, v58, v101, v103
    v_max3_u32 v58, v58, v105, v107
    v_max3_u32 v58, v58, v109, v111
    v_max3_u32 v58, v58, v113, v115
    v_max3_u32 v58, v58, v117, v119
    v_max3_u32 v58, v58, v121, v123
    v_max3_u32 v58, v58, v125, v127
    v_cmp_ne_u32 vcc, v57, v58
    s_nop 0
    s_cbranch_vccz L_gb_ok
    s_sub_u32 s73, s73, 1
    s_cmp_eq_u32 s73, 0
    s_cbranch_scc1 L_gb_ok
    s_branch L_gb
L_gb_ok:
    v_add_f32 v64, v64, v72
    v_add_f32 v66, v66, v74
    v_add_f32 v68, v68, v76
    v_add_f32 v70, v70, v78
    v_add_f32 v64, v64, v80
    v_add_f32 v66, v66, v82
    v_add_f32 v68, v68, v84
    v_add_f32 v70, v70, v86
    v_add_f32 v64, v64, v88
    v_add_f32 v66, v66, v90
    v_add_f32 v68, v68, v92
    v_add_f32 v70, v70, v94
    v_add_f32 v64, v64, v96
    v_add_f32 v66, v66, v98
    v_add_f32 v68, v68, v100
    v_add_f32 v70, v70, v102
    v_add_f32 v64, v64, v104
    v_add_f32 v66, v66, v106
    v_add_f32 v68, v68, v108
    v_add_f32 v70, v70, v110
    v_add_f32 v64, v64, v112
    v_add_f32 v66, v66, v114
    v_add_f32 v68, v68, v116
    v_add_f32 v70, v70, v118
    v_add_f32 v64, v64, v120
    v_add_f32 v66, v66, v122
    v_add_f32 v68, v68, v124
    v_add_f32 v70, v70, v126
    v_mov_b32 v24, v64
    v_mov_b32 v25, v66
    v_mov_b32 v26, v68
    v_mov_b32 v27, v70
    v_permlane16_swap_b32 v64, v24
    v_permlane16_swap_b32 v66, v25
    v_permlane16_swap_b32 v68, v26
    v_permlane16_swap_b32 v70, v27
    v_add_f32 v64, v64, v24
    v_add_f32 v66, v66, v25
    v_add_f32 v68, v68, v26
    v_add_f32 v70, v70, v27
    v_mov_b32 v24, v64
    v_mov_b32 v25, v66
    v_mov_b32 v26, v68
    v_mov_b32 v27, v70
    v_permlane32_swap_b32 v64, v24
    v_permlane32_swap_b32 v66, v25
    v_permlane32_swap_b32 v68, v26
    v_permlane32_swap_b32 v70, v27
    v_add_f32 v64, v64, v24
    v_add_f32 v66, v66, v25
    v_add_f32 v68, v68, v26
    v_add_f32 v70, v70, v27
    v_cvt_pk_bf16_f32 v64, 0, v64
    v_cvt_pk_bf16_f32 v66, 0, v66
    v_cvt_pk_bf16_f32 v68, 0, v68
    v_cvt_pk_bf16_f32 v70, 0, v70
    s_waitcnt vmcnt(0)
    s_mov_b32 s73, 200000
    s_branch L_ga_t
L_ga:
    s_mov_b32 s69, 1572864
    buffer_load_dwordx4 v[128:131], v46, s[36:39], s69 offen sc1
    buffer_load_dwordx4 v[132:135], v46, s[36:39], s69 offen offset:16 sc1
    s_mov_b32 s69, 1591296
    buffer_load_dwordx4 v[136:139], v46, s[36:39], s69 offen sc1
    buffer_load_dwordx4 v[140:143], v46, s[36:39], s69 offen offset:16 sc1
    s_mov_b32 s69, 1609728
    buffer_load_dwordx4 v[144:147], v46, s[36:39], s69 offen sc1
    buffer_load_dwordx4 v[148:151], v46, s[36:39], s69 offen offset:16 sc1
    s_mov_b32 s69, 1628160
    buffer_load_dwordx4 v[152:155], v46, s[36:39], s69 offen sc1
    buffer_load_dwordx4 v[156:159], v46, s[36:39], s69 offen offset:16 sc1
    s_mov_b32 s69, 1646592
    buffer_load_dwordx4 v[160:163], v46, s[36:39], s69 offen sc1
    buffer_load_dwordx4 v[164:167], v46, s[36:39], s69 offen offset:16 sc1
    s_mov_b32 s69, 1665024
    buffer_load_dwordx4 v[168:171], v46, s[36:39], s69 offen sc1
    buffer_load_dwordx4 v[172:175], v46, s[36:39], s69 offen offset:16 sc1
    s_mov_b32 s69, 1683456
    buffer_load_dwordx4 v[176:179], v46, s[36:39], s69 offen sc1
    buffer_load_dwordx4 v[180:183], v46, s[36:39], s69 offen offset:16 sc1
    s_mov_b32 s69, 1701888
    buffer_load_dwordx4 v[184:187], v46, s[36:39], s69 offen sc1
    buffer_load_dwordx4 v[188:191], v46, s[36:39], s69 offen offset:16 sc1
    s_waitcnt vmcnt(0)
L_ga_t:
    v_min3_u32 v57, v129, v131, v59
    v_min3_u32 v57, v57, v133, v135
    v_min3_u32 v57, v57, v137, v139
    v_min3_u32 v57, v57, v141, v143
    v_min3_u32 v57, v57, v145, v147
    v_min3_u32 v57, v57, v149, v151
    v_min3_u32 v57, v57, v153, v155
    v_min3_u32 v57, v57, v157, v159
    v_min3_u32 v57, v57, v161, v163
    v_min3_u32 v57, v57, v165, v167
    v_min3_u32 v57, v57, v169, v171
    v_min3_u32 v57, v57, v173, v175
    v_min3_u32 v57, v57, v177, v179
    v_min3_u32 v57, v57, v181, v183
    v_min3_u32 v57, v57, v185, v187
    v_min3_u32 v57, v57, v189, v191
    v_max3_u32 v58, v129, v131, v59
    v_max3_u32 v58, v58, v133, v135
    v_max3_u32 v58, v58, v137, v139
    v_max3_u32 v58, v58, v141, v143
    v_max3_u32 v58, v58, v145, v147
    v_max3_u32 v58, v58, v149, v151
    v_max3_u32 v58, v58, v153, v155
    v_max3_u32 v58, v58, v157, v159
    v_max3_u32 v58, v58, v161, v163
    v_max3_u32 v58, v58, v165, v167
    v_max3_u32 v58, v58, v169, v171
    v_max3_u32 v58, v58, v173, v175
    v_max3_u32 v58, v58, v177, v179
    v_max3_u32 v58, v58, v181, v183
    v_max3_u32 v58, v58, v185, v187
    v_max3_u32 v58, v58, v189, v191
    v_cmp_ne_u32 vcc, v57, v58
    s_nop 0
    s_cbranch_vccz L_ga_ok
    s_sub_u32 s73, s73, 1
    s_cmp_eq_u32 s73, 0
    s_cbranch_scc1 L_ga_ok
    s_branch L_ga
L_ga_ok:
    v_add_f32 v128, v128, v136
    v_add_f32 v130, v130, v138
    v_add_f32 v132, v132, v140
    v_add_f32 v134, v134, v142
    v_add_f32 v128, v128, v144
    v_add_f32 v130, v130, v146
    v_add_f32 v132, v132, v148
    v_add_f32 v134, v134, v150
    v_add_f32 v128, v128, v152
    v_add_f32 v130, v130, v154
    v_add_f32 v132, v132, v156
    v_add_f32 v134, v134, v158
    v_add_f32 v128, v128, v160
    v_add_f32 v130, v130, v162
    v_add_f32 v132, v132, v164
    v_add_f32 v134, v134, v166
    v_add_f32 v128, v128, v168
    v_add_f32 v130, v130, v170
    v_add_f32 v132, v132, v172
    v_add_f32 v134, v134, v174
    v_add_f32 v128, v128, v176
    v_add_f32 v130, v130, v178
    v_add_f32 v132, v132, v180
    v_add_f32 v134, v134, v182
    v_add_f32 v128, v128, v184
    v_add_f32 v130, v130, v186
    v_add_f32 v132, v132, v188
    v_add_f32 v134, v134, v190
    v_mov_b32 v24, v128
    v_mov_b32 v25, v130
    v_mov_b32 v26, v132
    v_mov_b32 v27, v134
    v_permlane16_swap_b32 v128, v24
    v_permlane16_swap_b32 v130, v25
    v_permlane16_swap_b32 v132, v26
    v_permlane16_swap_b32 v134, v27
    v_add_f32 v128, v128, v24
    v_add_f32 v130, v130, v25
    v_add_f32 v132, v132, v26
    v_add_f32 v134, v134, v27
    v_mov_b32 v24, v128
    v_mov_b32 v25, v130
    v_mov_b32 v26, v132
    v_mov_b32 v27, v134
    v_permlane32_swap_b32 v128, v24
    v_permlane32_swap_b32 v130, v25
    v_permlane32_swap_b32 v132, v26
    v_permlane32_swap_b32 v134, v27
    v_add_f32 v128, v128, v24
    v_add_f32 v130, v130, v25
    v_add_f32 v132, v132, v26
    v_add_f32 v134, v134, v27
    v_mov_b32 v28, v128
    v_mov_b32 v29, v130
    v_mov_b32 v30, v132
    v_mov_b32 v31, v134
    v_lshlrev_b32 v16, 16, v4
    v_and_b32 v17, 0xffff0000, v4
    v_lshlrev_b32 v18, 16, v5
    v_and_b32 v19, 0xffff0000, v5
    v_cvt_pk_bf16_f32 v28, 0, v28
    v_add_f32 v16, v16, v28
    v_cvt_pk_bf16_f32 v16, 0, v16
    v_add_f32 v16, v16, v64
    v_cvt_pk_bf16_f32 v29, 0, v29
    v_add_f32 v17, v17, v29
    v_cvt_pk_bf16_f32 v17, 0, v17
    v_add_f32 v17, v17, v66
    v_cvt_pk_bf16_f32 v30, 0, v30
    v_add_f32 v18, v18, v30
    v_cvt_pk_bf16_f32 v18, 0, v18
    v_add_f32 v18, v18, v68
    v_cvt_pk_bf16_f32 v31, 0, v31
    v_add_f32 v19, v19, v31
    v_cvt_pk_bf16_f32 v19, 0, v19
    v_add_f32 v19, v19, v70
    v_cvt_pk_bf16_f32 v20, v16, v17
    v_cvt_pk_bf16_f32 v21, v18, v19
    s_mov_b64 exec, 0xffff
    buffer_store_dwordx2 v[20:21], v47, s[60:63], 0 offen
    s_cmp_eq_u32 s31, 0
    s_cselect_b32 s69, 2031616, 1073741824
    v_mov_b32 v57, s69
    s_mov_b64 exec, 1
    buffer_store_dword v59, v57, s[36:39], 0 offen sc1
    s_mov_b64 exec, -1
L_end:
    s_endpgm
.section .rodata,"a"
.p2align 6
.amdhsa_kernel parallel_sum__mha_block_cached__dense_activation_silu__decode_kernel
  .amdhsa_next_free_vgpr 256
  .amdhsa_next_free_sgpr 102
  .amdhsa_accum_offset 256
  .amdhsa_group_segment_fixed_size 0
  .amdhsa_kernarg_size 88
  .amdhsa_user_sgpr_count 2
  .amdhsa_user_sgpr_kernarg_segment_ptr 1
  .amdhsa_system_sgpr_workgroup_id_x 1
.end_amdhsa_kernel
```
